```python
import torch

def _softmax(x, axis=-1):
    return torch.softmax(x, dim=axis)
def _gelu(x):
    return torch.nn.functional.gelu(x, approximate="tanh")
def _silu(x):
    return torch.nn.functional.silu(x)
def _sigmoid(x):
    return torch.sigmoid(x)
def _layernorm(x, axis=-1, eps=1e-5):
    m = x.mean(dim=axis, keepdim=True)
    v = x.var(dim=axis, keepdim=True, unbiased=False)
    return (x - m) / torch.sqrt(v + eps)
def _scatter_add(tgt, idx, src, axis=0):
    return tgt.clone().index_add_(axis, idx, src)
def _segment_sum(src, seg, n):
    out = torch.zeros((n,) + src.shape[1:], dtype=src.dtype)
    return out.index_add_(0, seg, src)
def _pad(x, pw):
    flat = tuple(v for pair in reversed(pw) for v in pair)
    return torch.nn.functional.pad(x, flat)

kernel_name = 'gated_mix__ssm_conv_s4d__geglu_ffn__prompt'

def setup_inputs():

    _w = (lambda a: (lambda t: t.to(torch.bfloat16) if t.is_floating_point() else t)(torch.as_tensor(a)))
    def _A_setup():
        Bsz, L, D, N = 1, 2048, 640, 192
        return {
            "u": _w((lambda *s: torch.randn(*s, dtype=torch.bfloat16) * 0.05)(Bsz, L, D)),
            "log_A_real": _w((lambda *s: torch.randn(*s, dtype=torch.bfloat16) * 6.4)(D, N) * 0.5),
            "A_imag": _w((lambda *s: torch.randn(*s, dtype=torch.bfloat16) * 0.05)(D, N) * 3.14),
            "C_real": _w((lambda *s: torch.randn(*s, dtype=torch.bfloat16) * 0.05)(D, N) / N ** 0.5),
            "C_imag": _w((lambda *s: torch.randn(*s, dtype=torch.bfloat16) * 0.05)(D, N) / N ** 0.5),
            "log_dt": _w((lambda *s: torch.randn(*s, dtype=torch.bfloat16) * 0.05)(D) * 0.5 - 4.0),
            "D_skip": _w((lambda *s: torch.randn(*s, dtype=torch.bfloat16) * 0.05)(D)),
        }
    _A_in = _A_setup()

    def _B_setup():
        B, S, D, F = 1, 2048, 640, 1536
        return {
            "x": _w((lambda *s: torch.randn(*s, dtype=torch.bfloat16) * 0.05)(B, S, D)),
            "w_gate": _w((lambda *s: torch.randn(*s, dtype=torch.bfloat16) * 0.05)(D, F)),
            "w_up": _w((lambda *s: torch.randn(*s, dtype=torch.bfloat16) * 0.05)(D, F)),
            "w_down": _w((lambda *s: torch.randn(*s, dtype=torch.bfloat16) * 0.05)(F, D)),
        }
    _B_in = _B_setup()

    return {
        "A_u": _A_in["u"],
        "A_log_A_real": _A_in["log_A_real"],
        "A_A_imag": _A_in["A_imag"],
        "A_C_real": _A_in["C_real"],
        "A_C_imag": _A_in["C_imag"],
        "A_log_dt": _A_in["log_dt"],
        "A_D_skip": _A_in["D_skip"],
        "B_x": _B_in["x"],
        "B_w_gate": _B_in["w_gate"],
        "B_w_up": _B_in["w_up"],
        "B_w_down": _B_in["w_down"],
        "gate_w": _w((lambda *s: torch.randn(*s, dtype=torch.bfloat16) * 0.05)(640) * 16.0),
    }

def reference(A_u, A_log_A_real, A_A_imag, A_C_real, A_C_imag, A_log_dt, A_D_skip, B_x, B_w_gate, B_w_up, B_w_down, gate_w):
    def _A_ref(u, log_A_real, A_imag, C_real, C_imag, log_dt, D_skip):
        L = u.shape[1]
        dt = torch.exp(log_dt)
        A = -torch.exp(log_A_real) + 1j * A_imag
        C = (C_real + 1j * C_imag) * dt[:, None]
        pos = (lambda x, dt: x.to(dt))(torch.arange(L), log_dt.dtype)
        P = torch.exp((A * dt[:, None])[:, :, None] * pos[None, None, :])
        K = 2.0 * torch.einsum("dn,dnl->dl", C, P).real
        L2 = 2 * L
        u_t = (lambda x, *d: x.permute(*d))(u, 0, 2, 1)
        Kf = (lambda x, *a, **k: torch.fft.rfft(x.float(), *a, **k))(K, L2)
        Uf = (lambda x, *a, **k: torch.fft.rfft(x.float(), *a, **k))(u_t, L2)
        y = (lambda x, *a, **k: torch.fft.irfft(x, *a, **k).to(torch.bfloat16))(Uf * Kf[None, :, :], L2)[:, :, :L]
        y = (lambda x, *d: x.permute(*d))(y, 0, 2, 1)
        return y + u * D_skip[None, None, :]

    def _B_ref(x, w_gate, w_up, w_down):
        return (_gelu(x @ w_gate) * (x @ w_up)) @ w_down

    x = A_u
    g = _sigmoid((x * gate_w).sum(-1, keepdims=True))
    a = _A_ref(x, A_log_A_real, A_A_imag, A_C_real, A_C_imag, A_log_dt, A_D_skip)
    b = _B_ref(x, B_w_gate, B_w_up, B_w_down)
    return g * a + (1 - g) * b
```

```asm
; @launch grid=(256,1,1) block=(512,1,1) lds=163840
.amdgcn_target "amdgcn-amd-amdhsa--gfx950"
.text
.globl gated_mix__ssm_conv_s4d__geglu_ffn__prompt_kernel
.p2align 8
.type gated_mix__ssm_conv_s4d__geglu_ffn__prompt_kernel,@function
gated_mix__ssm_conv_s4d__geglu_ffn__prompt_kernel:
    s_getpc_b64 s[32:33]
    s_bfe_u32 s28, s2, 0x30003
    v_lshlrev_b32 v234, 7, v0
    s_mulk_i32 s28, 4352
    s_mov_b32 s35, 0x00020000
    s_add_u32 s34, s28, 4352
    buffer_load_dword v234, v234, s[32:35], s28 offen
    s_load_dwordx2 s[4:5], s[0:1], 0
    s_load_dwordx2 s[22:23], s[0:1], 112
    v_lshrrev_b32 v2, 6, v0
    s_cmp_ge_u32 s2, 256
    s_cbranch_scc1 Lexit
    v_and_b32 v1, 63, v0
    v_readfirstlane_b32 s3, v2
    s_and_b32 s28, s2, 7
    s_lshr_b32 s29, s2, 3
    s_cmp_lt_u32 s3, 4
    s_cbranch_scc1 Lnot_loader
    s_cmp_lg_u32 s3, 7
    s_cbranch_scc1 Lnot_gemm
    s_setprio 3
    s_load_dwordx2 s[32:33], s[0:1], 64
    s_load_dwordx2 s[36:37], s[0:1], 72
    s_load_dwordx2 s[40:41], s[0:1], 88
    s_lshr_b32 s30, s28, 2
    s_lshl_b32 s30, s30, 3
    s_lshr_b32 s31, s29, 2
    s_add_u32 s101, s30, s31
    s_and_b32 s30, s28, 3
    s_and_b32 s31, s29, 3
    s_lshl_b32 s14, s30, 2
    s_add_u32 s14, s14, s31
    s_mul_i32 s31, s31, 5
    s_add_u32 s31, s31, 1
    s_lshr_b32 s31, s31, 1
    s_lshr_b32 s30, s29, 2
    s_add_u32 s31, s31, s30
    s_lshr_b32 s30, s29, 4
    s_add_u32 s17, s31, s30
    s_cmp_ge_u32 s17, 10
    s_cselect_b32 s30, 10, 0
    s_sub_u32 s17, s17, s30
    v_lshrrev_b32 v8, 3, v1
    v_mul_u32_u24 v8, 1280, v8
    v_lshrrev_b32 v9, 4, v1
    v_and_b32 v10, 7, v1
    v_xor_b32 v9, v9, v10
    v_lshl_add_u32 v2, v9, 4, v8
    v_xor_b32 v3, 64, v2
    s_mul_i32 s64, s101, 163840
    s_lshl_b32 s70, s17, 7
    s_mov_b32 s6, 2621440
    s_add_u32 s70, s70, s64
    s_mov_b32 s7, s35
    s_mov_b32 m0, 40992
    v_add_u32 v32, 0, v2
    s_waitcnt lgkmcnt(0)
    buffer_load_dwordx4 v32, s[4:7], s70 offen offset:0  lds
    v_add_u32 v33, 9216, v2
    buffer_load_dwordx4 v33, s[4:7], s70 offen offset:1024  lds
    s_mul_i32 s65, s14, 192
    s_mov_b32 s48, s17
    s_mov_b32 s34, 1966080
    s_mov_b32 s38, s34
    s_mov_b32 s39, s35
    s_mov_b32 s42, 1280
    s_mov_b32 s43, s35
    v_add_u32 v34, 18432, v3
    buffer_load_dwordx4 v34, s[4:7], s70 offen offset:2048  lds
    s_lshl_b32 s70, s48, 7
    s_add_u32 s70, s70, s64
    s_mul_i32 s73, s48, 196608
    s_add_u32 s73, s73, s65
    s_add_u32 s48, s48, 1
    s_cmp_eq_u32 s48, 10
    s_cselect_b32 s48, 0, s48
    v_add_u32 v35, 27648, v3
    buffer_load_dwordx4 v35, s[4:7], s70 offen offset:3072  lds
    s_lshl_b32 s71, s48, 7
    s_add_u32 s71, s71, s64
    s_mul_i32 s74, s48, 196608
    s_add_u32 s74, s74, s65
    s_add_u32 s48, s48, 1
    s_cmp_eq_u32 s48, 10
    s_cselect_b32 s48, 0, s48
    s_mov_b32 m0, 45088
    v_add_u32 v36, 40960, v2
    buffer_load_dwordx4 v36, s[4:7], s70 offen offset:0  lds
    s_lshl_b32 s72, s48, 7
    s_add_u32 s72, s72, s64
    s_mul_i32 s75, s48, 196608
    s_add_u32 s75, s75, s65
    s_add_u32 s48, s48, 1
    s_cmp_eq_u32 s48, 10
    s_cselect_b32 s48, 0, s48
    v_add_u32 v37, 50176, v2
    buffer_load_dwordx4 v37, s[4:7], s70 offen offset:1024  lds
    s_add_u32 s28, s22, 14680064
    s_addc_u32 s29, s23, 0
    s_load_dword s12, s[28:29], 0
    v_lshlrev_b32 v11, 4, v10
    v_add_u32 v38, 59392, v3
    buffer_load_dwordx4 v38, s[4:7], s70 offen offset:2048  lds
    v_add_u32 v39, 68608, v3
    buffer_load_dwordx4 v39, s[4:7], s70 offen offset:3072  lds
    s_mov_b32 m0, 49184
    v_add_u32 v40, 81920, v2
    buffer_load_dwordx4 v40, s[4:7], s70 offen offset:0  lds
    v_add_u32 v41, 91136, v2
    buffer_load_dwordx4 v41, s[4:7], s70 offen offset:1024  lds
    v_add_u32 v42, 100352, v3
    buffer_load_dwordx4 v42, s[4:7], s70 offen offset:2048  lds
    v_add_u32 v43, 109568, v3
    buffer_load_dwordx4 v43, s[4:7], s70 offen offset:3072  lds
    s_mov_b32 m0, 53280
    v_add_u32 v44, 122880, v2
    buffer_load_dwordx4 v44, s[4:7], s70 offen offset:0  lds
    v_add_u32 v45, 132096, v2
    buffer_load_dwordx4 v45, s[4:7], s70 offen offset:1024  lds
    v_add_u32 v46, 141312, v3
    buffer_load_dwordx4 v46, s[4:7], s70 offen offset:2048  lds
    v_add_u32 v47, 150528, v3
    buffer_load_dwordx4 v47, s[4:7], s70 offen offset:3072  lds
    s_add_u32 s30, s17, 8
    s_cmp_ge_u32 s30, 10
    s_cselect_b32 s18, 10, 0
    s_sub_u32 s30, s30, s18
    s_lshl_b32 s30, s30, 7
    buffer_load_dwordx4 v[80:83], v11, s[40:43], s30 offen
    s_add_u32 s30, s17, 9
    s_cmp_ge_u32 s30, 10
    s_cselect_b32 s18, 10, 0
    s_sub_u32 s30, s30, s18
    s_lshl_b32 s30, s30, 7
    buffer_load_dwordx4 v[84:87], v11, s[40:43], s30 offen
    v_add_u32 v8, 0, v1
    v_mul_u32_u24 v9, 0x5556, v8
    v_lshrrev_b32 v9, 18, v9
    v_mul_u32_u24 v10, 12, v9
    v_sub_u32 v10, v8, v10
    v_mul_u32_u24 v9, 3072, v9
    v_lshl_add_u32 v4, v10, 4, v9
    v_add_u32 v8, 64, v1
    v_mul_u32_u24 v9, 0x5556, v8
    v_lshrrev_b32 v9, 18, v9
    v_mul_u32_u24 v10, 12, v9
    v_sub_u32 v10, v8, v10
    v_mul_u32_u24 v9, 3072, v9
    v_lshl_add_u32 v5, v10, 4, v9
    v_add_u32 v8, 128, v1
    v_mul_u32_u24 v9, 0x5556, v8
    v_lshrrev_b32 v9, 18, v9
    v_mul_u32_u24 v10, 12, v9
    v_sub_u32 v10, v8, v10
    v_mul_u32_u24 v9, 3072, v9
    v_lshl_add_u32 v6, v10, 4, v9
    s_mov_b32 m0, 57376
    v_add_u32 v48, 0, v4
    buffer_load_dwordx4 v48, s[32:35], s73 offen offset:0  lds
    v_add_u32 v49, -1024, v5
    buffer_load_dwordx4 v49, s[32:35], s73 offen offset:1024  lds
    v_add_u32 v50, -2048, v6
    buffer_load_dwordx4 v50, s[32:35], s73 offen offset:2048  lds
    v_add_u32 v51, 46080, v4
    buffer_load_dwordx4 v51, s[32:35], s73 offen offset:3072  lds
    s_mov_b32 m0, 61472
    v_add_u32 v52, 49152, v5
    buffer_load_dwordx4 v52, s[32:35], s73 offen offset:0  lds
    v_add_u32 v53, 48128, v6
    buffer_load_dwordx4 v53, s[32:35], s73 offen offset:1024  lds
    v_add_u32 v54, 96256, v4
    buffer_load_dwordx4 v54, s[32:35], s73 offen offset:2048  lds
    v_add_u32 v55, 95232, v5
    buffer_load_dwordx4 v55, s[32:35], s73 offen offset:3072  lds
    s_mov_b32 m0, 65568
    v_add_u32 v56, 98304, v6
    buffer_load_dwordx4 v56, s[32:35], s73 offen offset:0  lds
    v_add_u32 v57, 146432, v4
    buffer_load_dwordx4 v57, s[32:35], s73 offen offset:1024  lds
    v_add_u32 v58, 145408, v5
    buffer_load_dwordx4 v58, s[32:35], s73 offen offset:2048  lds
    v_add_u32 v59, 144384, v6
    buffer_load_dwordx4 v59, s[32:35], s73 offen offset:3072  lds
    s_mov_b32 s8, s22
    s_mov_b32 s9, s23
    s_mov_b32 s10, 33554432
    s_mov_b32 s11, 0x00020000
    s_and_b32 s28, s2, 7
    s_lshr_b32 s29, s2, 3
    s_lshr_b32 s30, s29, 3
    s_lshl_b32 s15, s28, 2
    s_add_u32 s15, s15, s30
    s_and_b32 s16, s29, 7
    s_mul_i32 s30, s30, 3
    s_mul_i32 s31, s16, 3
    s_lshr_b32 s31, s31, 1
    s_add_u32 s98, s30, s31
    s_cmp_ge_u32 s98, 12
    s_cselect_b32 s30, 12, 0
    s_sub_u32 s98, s98, s30
    s_lshr_b32 s29, s29, 1
    s_lshl_b32 s29, s29, 3
    s_add_u32 s99, s29, s28
    s_lshr_b32 s28, s15, 1
    s_lshl_b32 s28, s28, 7
    s_and_b32 s29, s15, 1
    s_lshl_b32 s29, s29, 3
    s_add_u32 s100, s28, s29
    v_lshrrev_b32 v13, 3, v1
    s_lshl_b32 s28, s14, 10
    s_lshl_b32 s29, s14, 1
    s_and_b32 s29, s29, 4
    v_and_b32 v14, 7, v1
    v_lshrrev_b32 v12, 4, v1
    v_xor_b32 v12, v14, v12
    v_xor_b32 v12, s29, v12
    v_lshlrev_b32 v12, 4, v12
    v_lshl_add_u32 v12, v13, 7, v12
    v_add_u32 v12, s28, v12
    s_mov_b32 s57, 0
    v_mov_b32 v24, 0
    v_mov_b32 v25, 0
    v_mov_b32 v26, 0
    v_mov_b32 v27, 0
    v_mov_b32 v30, 163680
    v_lshrrev_b32 v31, 3, v1
    v_lshl_add_u32 v31, v31, 2, v30
    v_add_u32 v8, 0, v1
    v_mul_u32_u24 v9, 0x199a, v8
    v_lshrrev_b32 v9, 16, v9
    v_mul_u32_u24 v10, 10, v9
    v_sub_u32 v10, v8, v10
    v_and_b32 v66, -8, v9
    v_add_u32 v9, v9, v66
    v_mul_u32_u24 v9, 1280, v9
    v_lshl_add_u32 v66, v10, 4, v9
    v_add_u32 v8, 64, v1
    v_mul_u32_u24 v9, 0x199a, v8
    v_lshrrev_b32 v9, 16, v9
    v_mul_u32_u24 v10, 10, v9
    v_sub_u32 v10, v8, v10
    v_and_b32 v67, -8, v9
    v_add_u32 v9, v9, v67
    v_mul_u32_u24 v9, 1280, v9
    v_lshl_add_u32 v67, v10, 4, v9
    v_add_u32 v8, 128, v1
    v_mul_u32_u24 v9, 0x199a, v8
    v_lshrrev_b32 v9, 16, v9
    v_mul_u32_u24 v10, 10, v9
    v_sub_u32 v10, v8, v10
    v_and_b32 v68, -8, v9
    v_add_u32 v9, v9, v68
    v_mul_u32_u24 v9, 1280, v9
    v_lshl_add_u32 v68, v10, 4, v9
    v_add_u32 v8, 192, v1
    v_mul_u32_u24 v9, 0x199a, v8
    v_lshrrev_b32 v9, 16, v9
    v_mul_u32_u24 v10, 10, v9
    v_sub_u32 v10, v8, v10
    v_and_b32 v69, -8, v9
    v_add_u32 v9, v9, v69
    v_mul_u32_u24 v9, 1280, v9
    v_lshl_add_u32 v69, v10, 4, v9
    v_add_u32 v8, 256, v1
    v_mul_u32_u24 v9, 0x199a, v8
    v_lshrrev_b32 v9, 16, v9
    v_mul_u32_u24 v10, 10, v9
    v_sub_u32 v10, v8, v10
    v_and_b32 v70, -8, v9
    v_add_u32 v9, v9, v70
    v_mul_u32_u24 v9, 1280, v9
    v_lshl_add_u32 v70, v10, 4, v9
    v_add_u32 v8, 320, v1
    v_mul_u32_u24 v9, 0x199a, v8
    v_lshrrev_b32 v9, 16, v9
    v_mul_u32_u24 v10, 10, v9
    v_sub_u32 v10, v8, v10
    v_and_b32 v71, -8, v9
    v_add_u32 v9, v9, v71
    v_mul_u32_u24 v9, 1280, v9
    v_lshl_add_u32 v71, v10, 4, v9
    v_add_u32 v8, 384, v1
    v_mul_u32_u24 v9, 0x199a, v8
    v_lshrrev_b32 v9, 16, v9
    v_mul_u32_u24 v10, 10, v9
    v_sub_u32 v10, v8, v10
    v_and_b32 v72, -8, v9
    v_add_u32 v9, v9, v72
    v_mul_u32_u24 v9, 1280, v9
    v_lshl_add_u32 v72, v10, 4, v9
    v_add_u32 v8, 448, v1
    v_mul_u32_u24 v9, 0x199a, v8
    v_lshrrev_b32 v9, 16, v9
    v_mul_u32_u24 v10, 10, v9
    v_sub_u32 v10, v8, v10
    v_and_b32 v73, -8, v9
    v_add_u32 v9, v9, v73
    v_mul_u32_u24 v9, 1280, v9
    v_lshl_add_u32 v73, v10, 4, v9
    v_add_u32 v8, 512, v1
    v_mul_u32_u24 v9, 0x199a, v8
    v_lshrrev_b32 v9, 16, v9
    v_mul_u32_u24 v10, 10, v9
    v_sub_u32 v10, v8, v10
    v_and_b32 v74, -8, v9
    v_add_u32 v9, v9, v74
    v_mul_u32_u24 v9, 1280, v9
    v_lshl_add_u32 v74, v10, 4, v9
    v_add_u32 v8, 576, v1
    v_mul_u32_u24 v9, 0x199a, v8
    v_lshrrev_b32 v9, 16, v9
    v_mul_u32_u24 v10, 10, v9
    v_sub_u32 v10, v8, v10
    v_and_b32 v75, -8, v9
    v_add_u32 v9, v9, v75
    v_mul_u32_u24 v9, 1280, v9
    v_lshl_add_u32 v75, v10, 4, v9
    v_lshrrev_b32 v76, 3, v1
    v_lshlrev_b32 v76, 12, v76
    v_and_b32 v8, 7, v1
    v_lshl_add_u32 v76, v8, 4, v76
    v_mov_b32 v9, 1
    v_lshlrev_b32 v77, 3, v1
    v_lshlrev_b32 v2, 4, v1
    s_and_b32 s28, s14, 1
    s_sub_u32 s67, 3, s28
    s_lshl_b32 s29, s101, 1
    s_add_u32 s29, s29, s28
    s_lshl_b32 s29, s29, 9
    s_lshr_b32 s31, s14, 1
    s_lshl_b32 s31, s31, 6
    s_add_u32 s29, s29, s31
    s_add_u32 s68, s29, 14745600
    s_waitcnt lgkmcnt(0)
    s_mul_i32 s12, s12, 0x9E3779B1
    s_add_u32 s12, s12, 0x7F4A7C15
    s_mov_b32 s13, s12
    s_mov_b32 m0, 69696
    s_nop 0
    buffer_load_dwordx4 v48, s[36:39], s73 offen offset:0  lds
    buffer_load_dwordx4 v49, s[36:39], s73 offen offset:1024  lds
    buffer_load_dwordx4 v50, s[36:39], s73 offen offset:2048  lds
    buffer_load_dwordx4 v51, s[36:39], s73 offen offset:3072  lds
    s_mov_b32 m0, 73792
    s_nop 0
    buffer_load_dwordx4 v52, s[36:39], s73 offen offset:0  lds
    buffer_load_dwordx4 v53, s[36:39], s73 offen offset:1024  lds
    buffer_load_dwordx4 v54, s[36:39], s73 offen offset:2048  lds
    buffer_load_dwordx4 v55, s[36:39], s73 offen offset:3072  lds
    s_mov_b32 m0, 77888
    s_nop 0
    buffer_load_dwordx4 v56, s[36:39], s73 offen offset:0  lds
    buffer_load_dwordx4 v57, s[36:39], s73 offen offset:1024  lds
    buffer_load_dwordx4 v58, s[36:39], s73 offen offset:2048  lds
    buffer_load_dwordx4 v59, s[36:39], s73 offen offset:3072  lds
    s_and_b32 s28, s101, 3
    s_cmp_eq_u32 s28, 3
    s_cbranch_scc1 Lord2
    s_mov_b32 m0, 81984
    s_nop 0
    buffer_load_dwordx4 v32, s[4:7], s71 offen offset:0  lds
    buffer_load_dwordx4 v33, s[4:7], s71 offen offset:1024  lds
    buffer_load_dwordx4 v34, s[4:7], s71 offen offset:2048  lds
    buffer_load_dwordx4 v35, s[4:7], s71 offen offset:3072  lds
    s_mov_b32 m0, 86080
    s_nop 0
    buffer_load_dwordx4 v36, s[4:7], s71 offen offset:0  lds
    buffer_load_dwordx4 v37, s[4:7], s71 offen offset:1024  lds
    buffer_load_dwordx4 v38, s[4:7], s71 offen offset:2048  lds
    buffer_load_dwordx4 v39, s[4:7], s71 offen offset:3072  lds
    s_mov_b32 m0, 90176
    s_nop 0
    buffer_load_dwordx4 v40, s[4:7], s71 offen offset:0  lds
    buffer_load_dwordx4 v41, s[4:7], s71 offen offset:1024  lds
    buffer_load_dwordx4 v42, s[4:7], s71 offen offset:2048  lds
    buffer_load_dwordx4 v43, s[4:7], s71 offen offset:3072  lds
    s_mov_b32 m0, 94272
    s_nop 0
    buffer_load_dwordx4 v44, s[4:7], s71 offen offset:0  lds
    buffer_load_dwordx4 v45, s[4:7], s71 offen offset:1024  lds
    buffer_load_dwordx4 v46, s[4:7], s71 offen offset:2048  lds
    buffer_load_dwordx4 v47, s[4:7], s71 offen offset:3072  lds
    s_mov_b32 m0, 0
    s_nop 0
    buffer_load_dwordx4 v32, s[4:7], s72 offen offset:0  lds
    buffer_load_dwordx4 v33, s[4:7], s72 offen offset:1024  lds
    buffer_load_dwordx4 v34, s[4:7], s72 offen offset:2048  lds
    buffer_load_dwordx4 v35, s[4:7], s72 offen offset:3072  lds
    s_mov_b32 m0, 4096
    s_nop 0
    buffer_load_dwordx4 v36, s[4:7], s72 offen offset:0  lds
    buffer_load_dwordx4 v37, s[4:7], s72 offen offset:1024  lds
    buffer_load_dwordx4 v38, s[4:7], s72 offen offset:2048  lds
    s_waitcnt vmcnt(23) lgkmcnt(0)
    s_barrier
    buffer_load_dwordx4 v39, s[4:7], s72 offen offset:3072  lds
    s_mov_b32 m0, 8192
    s_nop 0
    buffer_load_dwordx4 v40, s[4:7], s72 offen offset:0  lds
    buffer_load_dwordx4 v41, s[4:7], s72 offen offset:1024  lds
    buffer_load_dwordx4 v42, s[4:7], s72 offen offset:2048  lds
    buffer_load_dwordx4 v43, s[4:7], s72 offen offset:3072  lds
    s_mov_b32 m0, 12288
    s_nop 0
    buffer_load_dwordx4 v44, s[4:7], s72 offen offset:0  lds
    buffer_load_dwordx4 v45, s[4:7], s72 offen offset:1024  lds
    buffer_load_dwordx4 v46, s[4:7], s72 offen offset:2048  lds
    buffer_load_dwordx4 v47, s[4:7], s72 offen offset:3072  lds
    s_mov_b32 m0, 98368
    s_nop 0
    buffer_load_dwordx4 v48, s[32:35], s74 offen offset:0  lds
    buffer_load_dwordx4 v49, s[32:35], s74 offen offset:1024  lds
    buffer_load_dwordx4 v50, s[32:35], s74 offen offset:2048  lds
    buffer_load_dwordx4 v51, s[32:35], s74 offen offset:3072  lds
    s_mov_b32 m0, 102464
    s_nop 0
    buffer_load_dwordx4 v52, s[32:35], s74 offen offset:0  lds
    buffer_load_dwordx4 v53, s[32:35], s74 offen offset:1024  lds
    buffer_load_dwordx4 v54, s[32:35], s74 offen offset:2048  lds
    buffer_load_dwordx4 v55, s[32:35], s74 offen offset:3072  lds
    s_mov_b32 m0, 106560
    s_nop 0
    buffer_load_dwordx4 v56, s[32:35], s74 offen offset:0  lds
    buffer_load_dwordx4 v57, s[32:35], s74 offen offset:1024  lds
    buffer_load_dwordx4 v58, s[32:35], s74 offen offset:2048  lds
    buffer_load_dwordx4 v59, s[32:35], s74 offen offset:3072  lds
    s_mov_b32 m0, 110688
    s_nop 0
    buffer_load_dwordx4 v48, s[36:39], s74 offen offset:0  lds
    buffer_load_dwordx4 v49, s[36:39], s74 offen offset:1024  lds
    buffer_load_dwordx4 v50, s[36:39], s74 offen offset:2048  lds
    buffer_load_dwordx4 v51, s[36:39], s74 offen offset:3072  lds
    s_mov_b32 m0, 114784
    s_nop 0
    buffer_load_dwordx4 v52, s[36:39], s74 offen offset:0  lds
    buffer_load_dwordx4 v53, s[36:39], s74 offen offset:1024  lds
    buffer_load_dwordx4 v54, s[36:39], s74 offen offset:2048  lds
    buffer_load_dwordx4 v55, s[36:39], s74 offen offset:3072  lds
    s_mov_b32 m0, 118880
    s_nop 0
    buffer_load_dwordx4 v56, s[36:39], s74 offen offset:0  lds
    buffer_load_dwordx4 v57, s[36:39], s74 offen offset:1024  lds
    buffer_load_dwordx4 v58, s[36:39], s74 offen offset:2048  lds
    buffer_load_dwordx4 v59, s[36:39], s74 offen offset:3072  lds
    s_mov_b32 m0, 16384
    s_nop 0
    buffer_load_dwordx4 v48, s[32:35], s75 offen offset:0  lds
    buffer_load_dwordx4 v49, s[32:35], s75 offen offset:1024  lds
    buffer_load_dwordx4 v50, s[32:35], s75 offen offset:2048  lds
    buffer_load_dwordx4 v51, s[32:35], s75 offen offset:3072  lds
    s_mov_b32 m0, 20480
    s_nop 0
    buffer_load_dwordx4 v52, s[32:35], s75 offen offset:0  lds
    buffer_load_dwordx4 v53, s[32:35], s75 offen offset:1024  lds
    buffer_load_dwordx4 v54, s[32:35], s75 offen offset:2048  lds
    buffer_load_dwordx4 v55, s[32:35], s75 offen offset:3072  lds
    s_mov_b32 m0, 24576
    s_nop 0
    buffer_load_dwordx4 v56, s[32:35], s75 offen offset:0  lds
    buffer_load_dwordx4 v57, s[32:35], s75 offen offset:1024  lds
    buffer_load_dwordx4 v58, s[32:35], s75 offen offset:2048  lds
    buffer_load_dwordx4 v59, s[32:35], s75 offen offset:3072  lds
    s_mov_b32 m0, 28704
    s_nop 0
    buffer_load_dwordx4 v48, s[36:39], s75 offen offset:0  lds
    buffer_load_dwordx4 v49, s[36:39], s75 offen offset:1024  lds
    buffer_load_dwordx4 v50, s[36:39], s75 offen offset:2048  lds
    buffer_load_dwordx4 v51, s[36:39], s75 offen offset:3072  lds
    s_mov_b32 m0, 32800
    s_nop 0
    buffer_load_dwordx4 v52, s[36:39], s75 offen offset:0  lds
    buffer_load_dwordx4 v53, s[36:39], s75 offen offset:1024  lds
    buffer_load_dwordx4 v54, s[36:39], s75 offen offset:2048  lds
    buffer_load_dwordx4 v55, s[36:39], s75 offen offset:3072  lds
    s_mov_b32 m0, 36896
    s_nop 0
    buffer_load_dwordx4 v56, s[36:39], s75 offen offset:0  lds
    buffer_load_dwordx4 v57, s[36:39], s75 offen offset:1024  lds
    buffer_load_dwordx4 v58, s[36:39], s75 offen offset:2048  lds
    buffer_load_dwordx4 v59, s[36:39], s75 offen offset:3072  lds
    s_waitcnt vmcnt(24) lgkmcnt(0)
    s_barrier
    s_branch Lord3
Lord2:
    s_mov_b32 m0, 98368
    s_nop 0
    buffer_load_dwordx4 v48, s[32:35], s74 offen offset:0  lds
    buffer_load_dwordx4 v49, s[32:35], s74 offen offset:1024  lds
    buffer_load_dwordx4 v50, s[32:35], s74 offen offset:2048  lds
    buffer_load_dwordx4 v51, s[32:35], s74 offen offset:3072  lds
    s_mov_b32 m0, 102464
    s_nop 0
    buffer_load_dwordx4 v52, s[32:35], s74 offen offset:0  lds
    buffer_load_dwordx4 v53, s[32:35], s74 offen offset:1024  lds
    buffer_load_dwordx4 v54, s[32:35], s74 offen offset:2048  lds
    buffer_load_dwordx4 v55, s[32:35], s74 offen offset:3072  lds
    s_mov_b32 m0, 106560
    s_nop 0
    buffer_load_dwordx4 v56, s[32:35], s74 offen offset:0  lds
    buffer_load_dwordx4 v57, s[32:35], s74 offen offset:1024  lds
    buffer_load_dwordx4 v58, s[32:35], s74 offen offset:2048  lds
    buffer_load_dwordx4 v59, s[32:35], s74 offen offset:3072  lds
    s_mov_b32 m0, 110688
    s_nop 0
    buffer_load_dwordx4 v48, s[36:39], s74 offen offset:0  lds
    buffer_load_dwordx4 v49, s[36:39], s74 offen offset:1024  lds
    buffer_load_dwordx4 v50, s[36:39], s74 offen offset:2048  lds
    buffer_load_dwordx4 v51, s[36:39], s74 offen offset:3072  lds
    s_mov_b32 m0, 114784
    s_nop 0
    buffer_load_dwordx4 v52, s[36:39], s74 offen offset:0  lds
    s_waitcnt vmcnt(17) lgkmcnt(0)
    s_barrier
    buffer_load_dwordx4 v53, s[36:39], s74 offen offset:1024  lds
    buffer_load_dwordx4 v54, s[36:39], s74 offen offset:2048  lds
    buffer_load_dwordx4 v55, s[36:39], s74 offen offset:3072  lds
    s_mov_b32 m0, 118880
    s_nop 0
    buffer_load_dwordx4 v56, s[36:39], s74 offen offset:0  lds
    buffer_load_dwordx4 v57, s[36:39], s74 offen offset:1024  lds
    buffer_load_dwordx4 v58, s[36:39], s74 offen offset:2048  lds
    buffer_load_dwordx4 v59, s[36:39], s74 offen offset:3072  lds
    s_mov_b32 m0, 81984
    s_nop 0
    buffer_load_dwordx4 v32, s[4:7], s71 offen offset:0  lds
    buffer_load_dwordx4 v33, s[4:7], s71 offen offset:1024  lds
    buffer_load_dwordx4 v34, s[4:7], s71 offen offset:2048  lds
    buffer_load_dwordx4 v35, s[4:7], s71 offen offset:3072  lds
    s_mov_b32 m0, 86080
    s_nop 0
    buffer_load_dwordx4 v36, s[4:7], s71 offen offset:0  lds
    buffer_load_dwordx4 v37, s[4:7], s71 offen offset:1024  lds
    buffer_load_dwordx4 v38, s[4:7], s71 offen offset:2048  lds
    buffer_load_dwordx4 v39, s[4:7], s71 offen offset:3072  lds
    s_mov_b32 m0, 90176
    s_nop 0
    buffer_load_dwordx4 v40, s[4:7], s71 offen offset:0  lds
    buffer_load_dwordx4 v41, s[4:7], s71 offen offset:1024  lds
    buffer_load_dwordx4 v42, s[4:7], s71 offen offset:2048  lds
    buffer_load_dwordx4 v43, s[4:7], s71 offen offset:3072  lds
    s_mov_b32 m0, 94272
    s_nop 0
    buffer_load_dwordx4 v44, s[4:7], s71 offen offset:0  lds
    buffer_load_dwordx4 v45, s[4:7], s71 offen offset:1024  lds
    buffer_load_dwordx4 v46, s[4:7], s71 offen offset:2048  lds
    buffer_load_dwordx4 v47, s[4:7], s71 offen offset:3072  lds
    s_mov_b32 m0, 0
    s_nop 0
    buffer_load_dwordx4 v32, s[4:7], s72 offen offset:0  lds
    buffer_load_dwordx4 v33, s[4:7], s72 offen offset:1024  lds
    buffer_load_dwordx4 v34, s[4:7], s72 offen offset:2048  lds
    buffer_load_dwordx4 v35, s[4:7], s72 offen offset:3072  lds
    s_mov_b32 m0, 4096
    s_nop 0
    buffer_load_dwordx4 v36, s[4:7], s72 offen offset:0  lds
    buffer_load_dwordx4 v37, s[4:7], s72 offen offset:1024  lds
    buffer_load_dwordx4 v38, s[4:7], s72 offen offset:2048  lds
    buffer_load_dwordx4 v39, s[4:7], s72 offen offset:3072  lds
    s_mov_b32 m0, 8192
    s_nop 0
    buffer_load_dwordx4 v40, s[4:7], s72 offen offset:0  lds
    buffer_load_dwordx4 v41, s[4:7], s72 offen offset:1024  lds
    buffer_load_dwordx4 v42, s[4:7], s72 offen offset:2048  lds
    buffer_load_dwordx4 v43, s[4:7], s72 offen offset:3072  lds
    s_mov_b32 m0, 12288
    s_nop 0
    buffer_load_dwordx4 v44, s[4:7], s72 offen offset:0  lds
    buffer_load_dwordx4 v45, s[4:7], s72 offen offset:1024  lds
    buffer_load_dwordx4 v46, s[4:7], s72 offen offset:2048  lds
    buffer_load_dwordx4 v47, s[4:7], s72 offen offset:3072  lds
    s_mov_b32 m0, 16384
    s_nop 0
    buffer_load_dwordx4 v48, s[32:35], s75 offen offset:0  lds
    buffer_load_dwordx4 v49, s[32:35], s75 offen offset:1024  lds
    buffer_load_dwordx4 v50, s[32:35], s75 offen offset:2048  lds
    buffer_load_dwordx4 v51, s[32:35], s75 offen offset:3072  lds
    s_mov_b32 m0, 20480
    s_nop 0
    buffer_load_dwordx4 v52, s[32:35], s75 offen offset:0  lds
    buffer_load_dwordx4 v53, s[32:35], s75 offen offset:1024  lds
    buffer_load_dwordx4 v54, s[32:35], s75 offen offset:2048  lds
    buffer_load_dwordx4 v55, s[32:35], s75 offen offset:3072  lds
    s_mov_b32 m0, 24576
    s_nop 0
    buffer_load_dwordx4 v56, s[32:35], s75 offen offset:0  lds
    buffer_load_dwordx4 v57, s[32:35], s75 offen offset:1024  lds
    buffer_load_dwordx4 v58, s[32:35], s75 offen offset:2048  lds
    buffer_load_dwordx4 v59, s[32:35], s75 offen offset:3072  lds
    s_mov_b32 m0, 28704
    s_nop 0
    buffer_load_dwordx4 v48, s[36:39], s75 offen offset:0  lds
    buffer_load_dwordx4 v49, s[36:39], s75 offen offset:1024  lds
    buffer_load_dwordx4 v50, s[36:39], s75 offen offset:2048  lds
    buffer_load_dwordx4 v51, s[36:39], s75 offen offset:3072  lds
    s_mov_b32 m0, 32800
    s_nop 0
    buffer_load_dwordx4 v52, s[36:39], s75 offen offset:0  lds
    buffer_load_dwordx4 v53, s[36:39], s75 offen offset:1024  lds
    buffer_load_dwordx4 v54, s[36:39], s75 offen offset:2048  lds
    buffer_load_dwordx4 v55, s[36:39], s75 offen offset:3072  lds
    s_mov_b32 m0, 36896
    s_nop 0
    buffer_load_dwordx4 v56, s[36:39], s75 offen offset:0  lds
    buffer_load_dwordx4 v57, s[36:39], s75 offen offset:1024  lds
    buffer_load_dwordx4 v58, s[36:39], s75 offen offset:2048  lds
    buffer_load_dwordx4 v59, s[36:39], s75 offen offset:3072  lds
    s_waitcnt vmcnt(40) lgkmcnt(0)
    s_barrier
Lord3:
    s_mov_b32 s49, 40992
    s_mov_b32 s58, 3
Lld1:
    s_lshl_b32 s50, s48, 7
    s_add_u32 s50, s50, s64
    s_mul_i32 s52, s48, 196608
    s_add_u32 s52, s52, s65
    s_add_u32 s48, s48, 1
    s_cmp_eq_u32 s48, 10
    s_cselect_b32 s48, 0, s48
    s_add_u32 m0, s49, 0
    s_nop 0
    buffer_load_dwordx4 v32, s[4:7], s50 offen offset:0  lds
    buffer_load_dwordx4 v33, s[4:7], s50 offen offset:1024  lds
    buffer_load_dwordx4 v34, s[4:7], s50 offen offset:2048  lds
    buffer_load_dwordx4 v35, s[4:7], s50 offen offset:3072  lds
    s_add_u32 m0, s49, 4096
    s_nop 0
    buffer_load_dwordx4 v36, s[4:7], s50 offen offset:0  lds
    buffer_load_dwordx4 v37, s[4:7], s50 offen offset:1024  lds
    buffer_load_dwordx4 v38, s[4:7], s50 offen offset:2048  lds
    buffer_load_dwordx4 v39, s[4:7], s50 offen offset:3072  lds
    s_add_u32 m0, s49, 8192
    s_nop 0
    buffer_load_dwordx4 v40, s[4:7], s50 offen offset:0  lds
    buffer_load_dwordx4 v41, s[4:7], s50 offen offset:1024  lds
    buffer_load_dwordx4 v42, s[4:7], s50 offen offset:2048  lds
    buffer_load_dwordx4 v43, s[4:7], s50 offen offset:3072  lds
    s_add_u32 m0, s49, 12288
    s_nop 0
    buffer_load_dwordx4 v44, s[4:7], s50 offen offset:0  lds
    buffer_load_dwordx4 v45, s[4:7], s50 offen offset:1024  lds
    buffer_load_dwordx4 v46, s[4:7], s50 offen offset:2048  lds
    buffer_load_dwordx4 v47, s[4:7], s50 offen offset:3072  lds
    s_add_u32 m0, s49, 16384
    s_nop 0
    buffer_load_dwordx4 v48, s[32:35], s52 offen offset:0  lds
    buffer_load_dwordx4 v49, s[32:35], s52 offen offset:1024  lds
    buffer_load_dwordx4 v50, s[32:35], s52 offen offset:2048  lds
    buffer_load_dwordx4 v51, s[32:35], s52 offen offset:3072  lds
    s_add_u32 m0, s49, 20480
    s_nop 0
    buffer_load_dwordx4 v52, s[32:35], s52 offen offset:0  lds
    buffer_load_dwordx4 v53, s[32:35], s52 offen offset:1024  lds
    buffer_load_dwordx4 v54, s[32:35], s52 offen offset:2048  lds
    buffer_load_dwordx4 v55, s[32:35], s52 offen offset:3072  lds
    s_add_u32 m0, s49, 24576
    s_nop 0
    buffer_load_dwordx4 v56, s[32:35], s52 offen offset:0  lds
    buffer_load_dwordx4 v57, s[32:35], s52 offen offset:1024  lds
    buffer_load_dwordx4 v58, s[32:35], s52 offen offset:2048  lds
    buffer_load_dwordx4 v59, s[32:35], s52 offen offset:3072  lds
    s_add_u32 m0, s49, 28704
    s_nop 0
    buffer_load_dwordx4 v48, s[36:39], s52 offen offset:0  lds
    buffer_load_dwordx4 v49, s[36:39], s52 offen offset:1024  lds
    buffer_load_dwordx4 v50, s[36:39], s52 offen offset:2048  lds
    buffer_load_dwordx4 v51, s[36:39], s52 offen offset:3072  lds
    s_add_u32 m0, s49, 32800
    s_nop 0
    buffer_load_dwordx4 v52, s[36:39], s52 offen offset:0  lds
    buffer_load_dwordx4 v53, s[36:39], s52 offen offset:1024  lds
    buffer_load_dwordx4 v54, s[36:39], s52 offen offset:2048  lds
    buffer_load_dwordx4 v55, s[36:39], s52 offen offset:3072  lds
    s_add_u32 m0, s49, 36896
    s_nop 0
    buffer_load_dwordx4 v56, s[36:39], s52 offen offset:0  lds
    buffer_load_dwordx4 v57, s[36:39], s52 offen offset:1024  lds
    buffer_load_dwordx4 v58, s[36:39], s52 offen offset:2048  lds
    buffer_load_dwordx4 v59, s[36:39], s52 offen offset:3072  lds
    s_add_u32 s49, s49, 40992
    s_cmp_eq_u32 s49, 122976
    s_cselect_b32 s49, 0, s49
    s_waitcnt vmcnt(40)
    s_barrier
    s_add_u32 s58, s58, 1
    s_cmp_lt_u32 s58, 10
    s_cbranch_scc1 Lld1
    s_lshl_b32 s19, s16, 7
    s_add_u32 s19, s19, 14692352
    s_load_dwordx16 s[20:35], s[8:9], s19 offset:0
    v_and_b32 v78, 15, v1
    v_lshlrev_b32 v78, 2, v78
    v_add_u32 v13, s57, v12
    s_add_u32 s57, s57, 40992
    ds_read_b128 v[16:19], v13
    s_cmp_eq_u32 s57, 122976
    s_cselect_b32 s57, 0, s57
    ds_read_b32 v28, v31 offset:96
    v_mov_b32 v29, 10
    s_waitcnt lgkmcnt(0)
    s_xor_b64 s[20:21], s[20:21], s[12:13]
    s_xor_b64 s[22:23], s[22:23], s[12:13]
    s_xor_b64 s[24:25], s[24:25], s[12:13]
    s_xor_b64 s[26:27], s[26:27], s[12:13]
    s_xor_b64 s[28:29], s[28:29], s[12:13]
    s_xor_b64 s[30:31], s[30:31], s[12:13]
    s_xor_b64 s[32:33], s[32:33], s[12:13]
    s_xor_b64 s[34:35], s[34:35], s[12:13]
    s_or_b64 s[20:21], s[20:21], s[22:23]
    s_or_b64 s[24:25], s[24:25], s[26:27]
    s_or_b64 s[28:29], s[28:29], s[30:31]
    s_or_b64 s[32:33], s[32:33], s[34:35]
    s_or_b64 s[20:21], s[20:21], s[24:25]
    s_or_b64 s[28:29], s[28:29], s[32:33]
    s_or_b64 s[20:21], s[20:21], s[28:29]
    s_cbranch_scc0 Lsc_1
    s_mov_b32 s18, 0
Lf_2:
    buffer_load_dword v79, v78, s[8:11], s19 offen sc1
    s_waitcnt vmcnt(0)
    v_cmp_ne_u32 vcc, s12, v79
    s_cbranch_vccz Lfd_3
    s_sleep 8
    s_add_u32 s18, s18, 1
    s_cmp_lt_u32 s18, 16384
    s_cbranch_scc1 Lf_2
Lfd_3:
Lsc_1:
    s_waitcnt vmcnt(0)
    s_mov_b64 exec, 1
    ds_write_b32 v30, v29 offset:32
    s_mov_b64 exec, -1
    v_add_u32 v13, s57, v12
    s_add_u32 s57, s57, 40992
    ds_read_b128 v[88:91], v13
    s_cmp_eq_u32 s57, 122976
    s_cselect_b32 s57, 0, s57
    s_load_dwordx2 s[40:41], s[0:1], 48
    s_mov_b32 s42, 1280
    s_mov_b32 s43, 0x00020000
    s_mul_i32 s50, s16, 245760
    s_add_u32 s50, s50, 6291456
    s_mov_b32 s58, 0
    v_mov_b32 v22, v30
Lwdl:
    s_cmp_lg_u32 s58, 2
    s_cbranch_scc1 Lwc_4
    ds_read_b32 v29, v22 offset:0
    s_waitcnt lgkmcnt(0)
    v_readfirstlane_b32 s31, v29
    s_cmp_ge_u32 s31, 4
    s_cbranch_scc1 Lcw_5
    s_waitcnt vmcnt(0)
    v_mov_b32 v29, s58
    s_mov_b64 exec, 1
    ds_write_b32 v22, v29 offset:40
    s_mov_b64 exec, -1
    s_mov_b32 s30, 0
Lp_6:
    ds_read_b32 v29, v22 offset:0
    s_waitcnt lgkmcnt(0)
    v_readfirstlane_b32 s31, v29
    s_cmp_ge_u32 s31, 4
    s_cbranch_scc1 Lpd_7
    s_sleep 1
    s_add_u32 s30, s30, 1
    s_cmp_lt_u32 s30, 262144
    s_cbranch_scc1 Lp_6
Lpd_7:
Lcw_5:
Lwc_4:
    s_cmp_lg_u32 s58, 4
    s_cbranch_scc1 Lwc_8
    ds_read_b32 v29, v22 offset:4
    s_waitcnt lgkmcnt(0)
    v_readfirstlane_b32 s31, v29
    s_cmp_ge_u32 s31, 4
    s_cbranch_scc1 Lcw_9
    s_waitcnt vmcnt(0)
    v_mov_b32 v29, s58
    s_mov_b64 exec, 1
    ds_write_b32 v22, v29 offset:40
    s_mov_b64 exec, -1
    s_mov_b32 s30, 0
Lp_10:
    ds_read_b32 v29, v22 offset:4
    s_waitcnt lgkmcnt(0)
    v_readfirstlane_b32 s31, v29
    s_cmp_ge_u32 s31, 4
    s_cbranch_scc1 Lpd_11
    s_sleep 1
    s_add_u32 s30, s30, 1
    s_cmp_lt_u32 s30, 262144
    s_cbranch_scc1 Lp_10
Lpd_11:
Lcw_9:
Lwc_8:
    s_lshl_b32 s52, s58, 2
    s_lshr_b32 s52, 0x85a976, s52
    s_and_b32 s52, s52, 15
    s_lshr_b32 s51, s58, 1
    s_add_u32 s51, s51, 2
    s_cmp_ge_u32 s51, 3
    s_cselect_b32 s18, 3, 0
    s_sub_u32 s51, s51, s18
    s_mul_i32 s51, s51, 40992
    s_bitcmp1_b32 s58, 0
    s_cselect_b32 s18, 20480, 0
    s_add_u32 s51, s51, s18
    s_add_u32 s53, s98, s52
    s_cmp_ge_u32 s53, 12
    s_cselect_b32 s18, 12, 0
    s_sub_u32 s53, s53, s18
    s_mul_i32 s53, s53, 5120
    s_add_u32 s53, s53, s50
    s_add_u32 m0, s51, 0
    s_add_u32 s30, s53, 0
    buffer_load_dwordx4 v2, s[8:11], s30 offen offset:0 sc1 lds
    buffer_load_dwordx4 v2, s[8:11], s30 offen offset:1024 sc1 lds
    buffer_load_dwordx4 v2, s[8:11], s30 offen offset:2048 sc1 lds
    buffer_load_dwordx4 v2, s[8:11], s30 offen offset:3072 sc1 lds
    s_add_u32 m0, s51, 4096
    s_add_u32 s30, s53, 4096
    buffer_load_dwordx4 v2, s[8:11], s30 offen sc1 lds
    s_add_u32 m0, s51, 5120
    s_add_u32 s30, s53, 61440
    buffer_load_dwordx4 v2, s[8:11], s30 offen offset:0 sc1 lds
    buffer_load_dwordx4 v2, s[8:11], s30 offen offset:1024 sc1 lds
    buffer_load_dwordx4 v2, s[8:11], s30 offen offset:2048 sc1 lds
    buffer_load_dwordx4 v2, s[8:11], s30 offen offset:3072 sc1 lds
    s_add_u32 m0, s51, 9216
    s_add_u32 s30, s53, 65536
    buffer_load_dwordx4 v2, s[8:11], s30 offen sc1 lds
    s_add_u32 m0, s51, 10240
    s_add_u32 s30, s53, 122880
    buffer_load_dwordx4 v2, s[8:11], s30 offen offset:0 sc1 lds
    buffer_load_dwordx4 v2, s[8:11], s30 offen offset:1024 sc1 lds
    buffer_load_dwordx4 v2, s[8:11], s30 offen offset:2048 sc1 lds
    buffer_load_dwordx4 v2, s[8:11], s30 offen offset:3072 sc1 lds
    s_add_u32 m0, s51, 14336
    s_add_u32 s30, s53, 126976
    buffer_load_dwordx4 v2, s[8:11], s30 offen sc1 lds
    s_add_u32 m0, s51, 15360
    s_add_u32 s30, s53, 184320
    buffer_load_dwordx4 v2, s[8:11], s30 offen offset:0 sc1 lds
    buffer_load_dwordx4 v2, s[8:11], s30 offen offset:1024 sc1 lds
    buffer_load_dwordx4 v2, s[8:11], s30 offen offset:2048 sc1 lds
    buffer_load_dwordx4 v2, s[8:11], s30 offen offset:3072 sc1 lds
    s_add_u32 m0, s51, 19456
    s_add_u32 s30, s53, 188416
    buffer_load_dwordx4 v2, s[8:11], s30 offen sc1 lds
    s_waitcnt vmcnt(20)
    v_mov_b32 v29, s58
    s_mov_b64 exec, 1
    ds_write_b32 v22, v29 offset:40
    s_mov_b64 exec, -1
    s_add_u32 s58, s58, 1
    s_cmp_lt_u32 s58, 6
    s_cbranch_scc1 Lwdl
    s_waitcnt lgkmcnt(0)
    v_dot2c_f32_bf16 v24, v80, v16
    v_dot2c_f32_bf16 v25, v81, v17
    v_dot2c_f32_bf16 v26, v82, v18
    v_dot2c_f32_bf16 v27, v83, v19
    v_dot2c_f32_bf16 v24, v84, v88
    v_dot2c_f32_bf16 v25, v85, v89
    v_dot2c_f32_bf16 v26, v86, v90
    v_dot2c_f32_bf16 v27, v87, v91
    s_mov_b32 s28, 0xbfb8aa3b
    s_mov_b32 s30, 0x01010101
    v_add_f32 v24, v24, v25
    v_add_f32 v26, v26, v27
    v_add_f32 v24, v24, v26
    s_nop 1
    v_add_f32_dpp v24, v24, v24 quad_perm:[1,0,3,2] row_mask:0xf bank_mask:0xf
    s_nop 1
    v_add_f32_dpp v24, v24, v24 quad_perm:[2,3,0,1] row_mask:0xf bank_mask:0xf
    s_nop 1
    v_add_f32_dpp v24, v24, v24 row_half_mirror row_mask:0xf bank_mask:0xf
    v_mov_b32 v25, s12
    v_add_f32 v24, v24, v28
    v_mul_f32 v24, s28, v24
    v_exp_f32 v24, v24
    s_nop 0
    v_add_f32 v24, 1.0, v24
    v_rcp_f32 v24, v24
    s_mov_b32 exec_lo, s30
    s_mov_b32 exec_hi, s30
    buffer_store_dwordx2 v[24:25], v1, s[8:11], s68 offen sc1
    s_mov_b64 exec, -1
    s_lshl_b32 s29, s15, 9
    s_add_u32 s29, s29, 14745600
    s_mov_b32 s30, 0
    s_waitcnt vmcnt(1)
    v_mov_b32 v29, 6
    s_mov_b64 exec, 1
    ds_write_b32 v22, v29 offset:40
    s_mov_b64 exec, -1
Lgp:
    buffer_load_dwordx2 v[24:25], v77, s[8:11], s29 offen sc1
    s_waitcnt vmcnt(0)
    v_cmp_ne_u32 vcc, s12, v25
    s_cbranch_vccz Lgpd
    s_sleep 1
    s_add_u32 s30, s30, 1
    s_cmp_lt_u32 s30, 16384
    s_cbranch_scc1 Lgp
Lgpd:
    v_sub_f32 v25, 1.0, v24
    v_lshlrev_b32 v26, 2, v1
    v_add_u32 v26, 143456, v26
    s_mul_i32 s48, s100, 1280
    s_mul_i32 s49, s16, 160
    s_add_u32 s48, s48, s49
    s_lshl_b32 s14, s16, 3
    s_and_b32 s29, s15, 7
    s_add_u32 s14, s14, s29
    s_lshl_b32 s14, s14, 9
    s_add_u32 s14, s14, 15007744
    v_min_u32 v28, 39, v1
    v_lshlrev_b32 v28, 3, v28
    s_mul_i32 s17, s16, 327680
    s_lshr_b32 s29, s15, 3
    s_lshl_b32 s29, s29, 10
    s_add_u32 s17, s17, s29
    s_and_b32 s29, s15, 1
    s_lshl_b32 s29, s29, 9
    s_add_u32 s17, s17, s29
    s_and_b32 s29, s15, 6
    s_lshl_b32 s29, s29, 6
    s_add_u32 s17, s17, s29
    s_add_u32 s17, s17, 11534336
    s_mov_b32 s30, 0
Lp_12:
    ds_read_b32 v29, v22 offset:48
    s_waitcnt lgkmcnt(0)
    v_readfirstlane_b32 s31, v29
    s_cmp_ge_u32 s31, s67
    s_cbranch_scc1 Lpd_13
    s_sleep 1
    s_add_u32 s30, s30, 1
    s_cmp_lt_u32 s30, 262144
    s_cbranch_scc1 Lp_12
Lpd_13:
    ds_write_b32 v26, v24
    ds_write_b32 v26, v25 offset:256
    s_mov_b32 m0, 133216
    s_nop 0
    buffer_load_dwordx4 v66, s[4:7], s48 offen lds
    s_mov_b32 m0, 134240
    s_nop 0
    buffer_load_dwordx4 v67, s[4:7], s48 offen lds
    s_mov_b32 m0, 135264
    s_nop 0
    buffer_load_dwordx4 v68, s[4:7], s48 offen lds
    s_mov_b32 m0, 136288
    s_nop 0
    buffer_load_dwordx4 v69, s[4:7], s48 offen lds
    s_mov_b32 m0, 137312
    s_nop 0
    buffer_load_dwordx4 v70, s[4:7], s48 offen lds
    s_mov_b32 m0, 138336
    s_nop 0
    buffer_load_dwordx4 v71, s[4:7], s48 offen lds
    s_mov_b32 m0, 139360
    s_nop 0
    buffer_load_dwordx4 v72, s[4:7], s48 offen lds
    s_mov_b32 m0, 140384
    s_nop 0
    buffer_load_dwordx4 v73, s[4:7], s48 offen lds
    s_mov_b32 m0, 141408
    s_nop 0
    buffer_load_dwordx4 v74, s[4:7], s48 offen lds
    s_mov_b32 m0, 142432
    s_nop 0
    buffer_load_dwordx4 v75, s[4:7], s48 offen lds
    s_mov_b32 m0, 143968
    s_mov_b64 exec, 0x3ff
    buffer_load_dwordx4 v2, s[40:43], s49 offen lds
    s_mov_b64 exec, -1
    s_waitcnt vmcnt(0) lgkmcnt(0)
    s_mov_b64 exec, 1
    ds_add_u32 v22, v9 offset:52
    s_mov_b64 exec, -1
    s_mov_b32 s18, 0
    s_mov_b32 s19, 0
Lyg_14:
    s_load_dwordx16 s[20:35], s[8:9], s14 offset:0 glc
    s_load_dwordx16 s[36:51], s[8:9], s14 offset:64 glc
    s_load_dwordx16 s[52:67], s[8:9], s14 offset:128 glc
    s_load_dwordx16 s[68:83], s[8:9], s14 offset:192 glc
    s_load_dwordx16 s[84:99], s[8:9], s14 offset:256 glc
    s_waitcnt lgkmcnt(0)
    s_cmp_gt_u32 s19, 0
    s_cbranch_scc1 Lyn_17
    s_xor_b64 s[20:21], s[20:21], s[12:13]
    s_xor_b64 s[22:23], s[22:23], s[12:13]
    s_xor_b64 s[24:25], s[24:25], s[12:13]
    s_xor_b64 s[26:27], s[26:27], s[12:13]
    s_xor_b64 s[28:29], s[28:29], s[12:13]
    s_xor_b64 s[30:31], s[30:31], s[12:13]
    s_xor_b64 s[32:33], s[32:33], s[12:13]
    s_xor_b64 s[34:35], s[34:35], s[12:13]
    s_or_b64 s[20:21], s[20:21], s[22:23]
    s_or_b64 s[24:25], s[24:25], s[26:27]
    s_or_b64 s[28:29], s[28:29], s[30:31]
    s_or_b64 s[32:33], s[32:33], s[34:35]
    s_or_b64 s[20:21], s[20:21], s[24:25]
    s_or_b64 s[28:29], s[28:29], s[32:33]
    s_or_b64 s[20:21], s[20:21], s[28:29]
    s_cbranch_scc1 Lyw_22
    s_mov_b32 m0, 122976
    s_nop 0
    buffer_load_dwordx4 v76, s[8:11], s17 offen sc1 lds
    s_add_u32 s17, s17, 32768
    s_mov_b32 m0, 124000
    s_nop 0
    buffer_load_dwordx4 v76, s[8:11], s17 offen sc1 lds
    s_add_u32 s17, s17, 32768
    s_mov_b32 s19, 1
Lyn_17:
    s_cmp_gt_u32 s19, 1
    s_cbranch_scc1 Lyn_18
    s_xor_b64 s[36:37], s[36:37], s[12:13]
    s_xor_b64 s[38:39], s[38:39], s[12:13]
    s_xor_b64 s[40:41], s[40:41], s[12:13]
    s_xor_b64 s[42:43], s[42:43], s[12:13]
    s_xor_b64 s[44:45], s[44:45], s[12:13]
    s_xor_b64 s[46:47], s[46:47], s[12:13]
    s_xor_b64 s[48:49], s[48:49], s[12:13]
    s_xor_b64 s[50:51], s[50:51], s[12:13]
    s_or_b64 s[36:37], s[36:37], s[38:39]
    s_or_b64 s[40:41], s[40:41], s[42:43]
    s_or_b64 s[44:45], s[44:45], s[46:47]
    s_or_b64 s[48:49], s[48:49], s[50:51]
    s_or_b64 s[36:37], s[36:37], s[40:41]
    s_or_b64 s[44:45], s[44:45], s[48:49]
    s_or_b64 s[36:37], s[36:37], s[44:45]
    s_cbranch_scc1 Lyw_22
    s_mov_b32 m0, 125024
    s_nop 0
    buffer_load_dwordx4 v76, s[8:11], s17 offen sc1 lds
    s_add_u32 s17, s17, 32768
    s_mov_b32 m0, 126048
    s_nop 0
    buffer_load_dwordx4 v76, s[8:11], s17 offen sc1 lds
    s_add_u32 s17, s17, 32768
    s_mov_b32 s19, 2
Lyn_18:
    s_cmp_gt_u32 s19, 2
    s_cbranch_scc1 Lyn_19
    s_xor_b64 s[52:53], s[52:53], s[12:13]
    s_xor_b64 s[54:55], s[54:55], s[12:13]
    s_xor_b64 s[56:57], s[56:57], s[12:13]
    s_xor_b64 s[58:59], s[58:59], s[12:13]
    s_xor_b64 s[60:61], s[60:61], s[12:13]
    s_xor_b64 s[62:63], s[62:63], s[12:13]
    s_xor_b64 s[64:65], s[64:65], s[12:13]
    s_xor_b64 s[66:67], s[66:67], s[12:13]
    s_or_b64 s[52:53], s[52:53], s[54:55]
    s_or_b64 s[56:57], s[56:57], s[58:59]
    s_or_b64 s[60:61], s[60:61], s[62:63]
    s_or_b64 s[64:65], s[64:65], s[66:67]
    s_or_b64 s[52:53], s[52:53], s[56:57]
    s_or_b64 s[60:61], s[60:61], s[64:65]
    s_or_b64 s[52:53], s[52:53], s[60:61]
    s_cbranch_scc1 Lyw_22
    s_mov_b32 m0, 127072
    s_nop 0
    buffer_load_dwordx4 v76, s[8:11], s17 offen sc1 lds
    s_add_u32 s17, s17, 32768
    s_mov_b32 m0, 128096
    s_nop 0
    buffer_load_dwordx4 v76, s[8:11], s17 offen sc1 lds
    s_add_u32 s17, s17, 32768
    s_mov_b32 s19, 3
Lyn_19:
    s_cmp_gt_u32 s19, 3
    s_cbranch_scc1 Lyn_20
    s_xor_b64 s[68:69], s[68:69], s[12:13]
    s_xor_b64 s[70:71], s[70:71], s[12:13]
    s_xor_b64 s[72:73], s[72:73], s[12:13]
    s_xor_b64 s[74:75], s[74:75], s[12:13]
    s_xor_b64 s[76:77], s[76:77], s[12:13]
    s_xor_b64 s[78:79], s[78:79], s[12:13]
    s_xor_b64 s[80:81], s[80:81], s[12:13]
    s_xor_b64 s[82:83], s[82:83], s[12:13]
    s_or_b64 s[68:69], s[68:69], s[70:71]
    s_or_b64 s[72:73], s[72:73], s[74:75]
    s_or_b64 s[76:77], s[76:77], s[78:79]
    s_or_b64 s[80:81], s[80:81], s[82:83]
    s_or_b64 s[68:69], s[68:69], s[72:73]
    s_or_b64 s[76:77], s[76:77], s[80:81]
    s_or_b64 s[68:69], s[68:69], s[76:77]
    s_cbranch_scc1 Lyw_22
    s_mov_b32 m0, 129120
    s_nop 0
    buffer_load_dwordx4 v76, s[8:11], s17 offen sc1 lds
    s_add_u32 s17, s17, 32768
    s_mov_b32 m0, 130144
    s_nop 0
    buffer_load_dwordx4 v76, s[8:11], s17 offen sc1 lds
    s_add_u32 s17, s17, 32768
    s_mov_b32 s19, 4
Lyn_20:
    s_cmp_gt_u32 s19, 4
    s_cbranch_scc1 Lyn_21
    s_xor_b64 s[84:85], s[84:85], s[12:13]
    s_xor_b64 s[86:87], s[86:87], s[12:13]
    s_xor_b64 s[88:89], s[88:89], s[12:13]
    s_xor_b64 s[90:91], s[90:91], s[12:13]
    s_xor_b64 s[92:93], s[92:93], s[12:13]
    s_xor_b64 s[94:95], s[94:95], s[12:13]
    s_xor_b64 s[96:97], s[96:97], s[12:13]
    s_xor_b64 s[98:99], s[98:99], s[12:13]
    s_or_b64 s[84:85], s[84:85], s[86:87]
    s_or_b64 s[88:89], s[88:89], s[90:91]
    s_or_b64 s[92:93], s[92:93], s[94:95]
    s_or_b64 s[96:97], s[96:97], s[98:99]
    s_or_b64 s[84:85], s[84:85], s[88:89]
    s_or_b64 s[92:93], s[92:93], s[96:97]
    s_or_b64 s[84:85], s[84:85], s[92:93]
    s_cbranch_scc1 Lyw_22
    s_mov_b32 m0, 131168
    s_nop 0
    buffer_load_dwordx4 v76, s[8:11], s17 offen sc1 lds
    s_add_u32 s17, s17, 32768
    s_mov_b32 m0, 132192
    s_nop 0
    buffer_load_dwordx4 v76, s[8:11], s17 offen sc1 lds
    s_add_u32 s17, s17, 32768
    s_mov_b32 s19, 5
Lyn_21:
    s_branch Lygd_16
Lyw_22:
    s_sleep 2
    s_add_u32 s18, s18, 1
    s_cmp_lt_u32 s18, 256
    s_cbranch_scc1 Lyg_14
    s_mov_b32 s18, 0
Lf_23:
    buffer_load_dwordx2 v[12:13], v28, s[8:11], s14 offen sc1
    s_waitcnt vmcnt(0)
    v_xor_b32 v12, s12, v12
    v_xor_b32 v13, s12, v13
    v_or_b32 v12, v12, v13
    v_cmp_ne_u32 vcc, 0, v12
    s_cbranch_vccz Lfd_24
    s_sleep 1
    s_add_u32 s18, s18, 1
    s_cmp_lt_u32 s18, 16384
    s_cbranch_scc1 Lf_23
Lfd_24:
Lygf_15:
    s_lshl_b32 s18, s19, 11
    s_add_u32 m0, s18, 122976
    s_nop 0
    buffer_load_dwordx4 v76, s[8:11], s17 offen sc1 lds
    s_add_u32 s17, s17, 32768
    s_add_u32 m0, s18, 124000
    s_nop 0
    buffer_load_dwordx4 v76, s[8:11], s17 offen sc1 lds
    s_add_u32 s17, s17, 32768
    s_add_u32 s19, s19, 1
    s_cmp_lt_u32 s19, 5
    s_cbranch_scc1 Lygf_15
Lygd_16:
    s_waitcnt vmcnt(0)
    s_mov_b64 exec, 1
    ds_add_u32 v22, v9 offset:56
    s_mov_b64 exec, -1
    s_endpgm
.p2align 7
Lnot_loader:
    s_lshr_b32 s30, s28, 2
    s_lshl_b32 s30, s30, 3
    s_lshr_b32 s31, s29, 2
    s_add_u32 s101, s30, s31
    s_and_b32 s30, s28, 3
    s_and_b32 s31, s29, 3
    s_lshl_b32 s14, s30, 2
    s_add_u32 s14, s14, s31
    s_mul_i32 s31, s31, 5
    s_add_u32 s31, s31, 1
    s_lshr_b32 s31, s31, 1
    s_lshr_b32 s30, s29, 2
    s_add_u32 s31, s31, s30
    s_lshr_b32 s30, s29, 4
    s_add_u32 s17, s31, s30
    s_cmp_ge_u32 s17, 10
    s_cselect_b32 s30, 10, 0
    s_sub_u32 s17, s17, s30
    s_setprio 3
    s_load_dwordx2 s[54:55], s[0:1], 96
    s_load_dwordx2 s[76:77], s[0:1], 48
    s_lshr_b32 s48, s3, 1
    s_and_b32 s49, s3, 1
    s_and_b32 s28, s2, 7
    s_lshr_b32 s29, s2, 3
    s_lshr_b32 s30, s29, 3
    s_lshl_b32 s15, s28, 2
    s_add_u32 s15, s15, s30
    s_and_b32 s16, s29, 7
    s_mul_i32 s30, s30, 3
    s_mul_i32 s31, s16, 3
    s_lshr_b32 s31, s31, 1
    s_add_u32 s98, s30, s31
    s_cmp_ge_u32 s98, 12
    s_cselect_b32 s30, 12, 0
    s_sub_u32 s98, s98, s30
    s_lshr_b32 s29, s29, 1
    s_lshl_b32 s29, s29, 3
    s_add_u32 s99, s29, s28
    s_lshr_b32 s28, s15, 1
    s_lshl_b32 s28, s28, 7
    s_and_b32 s29, s15, 1
    s_lshl_b32 s29, s29, 3
    s_add_u32 s100, s28, s29
    v_and_b32 v16, 31, v1
    s_lshl_b32 s28, s48, 10
    v_and_b32 v17, 24, v16
    v_add_u32 v17, v17, v16
    v_lshlrev_b32 v17, 7, v17
    v_add_u32 v17, s28, v17
    v_bfe_u32 v20, v16, 1, 3
    v_lshrrev_b32 v21, 5, v1
    v_xor_b32 v20, v20, v21
    v_xor_b32 v21, 0, v20
    v_lshl_add_u32 v108, v21, 4, v17
    v_xor_b32 v21, 2, v20
    v_lshl_add_u32 v109, v21, 4, v17
    v_xor_b32 v21, 4, v20
    v_lshl_add_u32 v110, v21, 4, v17
    v_xor_b32 v21, 6, v20
    v_lshl_add_u32 v111, v21, 4, v17
    v_lshrrev_b32 v16, 5, v1
    v_lshlrev_b32 v16, 3, v16
    v_bfe_u32 v17, v1, 2, 2
    v_add_u32 v16, v16, v17
    v_mul_u32_u24 v16, 192, v16
    v_bfe_u32 v17, v1, 4, 1
    v_mul_u32_u24 v17, 12320, v17
    v_add_u32 v16, v16, v17
    v_and_b32 v17, 3, v1
    v_lshl_add_u32 v16, v17, 3, v16
    s_mul_i32 s28, s49, 96
    s_add_u32 s28, s28, 16384
    v_add_u32 v112, s28, v16
    s_mov_b32 s47, 1
    s_mov_b32 s53, 40992
    s_mov_b32 s52, 40992
    v_mov_b32 v2, 1
    v_mov_b32 v3, 163680
    s_lshl_b32 s28, s3, 2
    s_add_u32 s28, s28, 163680
    v_mov_b32 v115, s28
    v_mov_b32 v113, 0
    v_lshlrev_b32 v0, 4, v1
    v_and_b32 v16, 15, v1
    v_lshlrev_b32 v16, 4, v16
    v_bfe_u32 v17, v1, 4, 1
    v_lshl_add_u32 v16, v17, 10, v16
    v_lshrrev_b32 v17, 5, v1
    v_lshl_add_u32 v5, v17, 8, v16
    s_waitcnt lgkmcnt(0)
    s_mov_b32 s8, s22
    s_mov_b32 s9, s23
    s_mov_b32 s10, 33554432
    s_mov_b32 s11, 0x00020000
    s_add_u32 s28, s22, 14680064
    s_addc_u32 s29, s23, 0
    s_load_dword s12, s[28:29], 0
    s_mov_b32 s68, s54
    s_mov_b32 s69, s55
    s_mov_b32 s70, 2621440
    s_mov_b32 s71, 0x00020000
    s_mov_b32 s36, s76
    s_mov_b32 s37, s77
    s_mov_b32 s38, 1280
    s_mov_b32 s39, 0x00020000
    v_mov_b32 v128, 0
    v_mov_b32 v129, 0
    v_mov_b32 v130, 0
    v_mov_b32 v131, 0
    v_mov_b32 v132, 0
    v_mov_b32 v133, 0
    v_mov_b32 v134, 0
    v_mov_b32 v135, 0
    v_mov_b32 v136, 0
    v_mov_b32 v137, 0
    v_mov_b32 v138, 0
    v_mov_b32 v139, 0
    v_mov_b32 v140, 0
    v_mov_b32 v141, 0
    v_mov_b32 v142, 0
    v_mov_b32 v143, 0
    v_mov_b32 v144, 0
    v_mov_b32 v145, 0
    v_mov_b32 v146, 0
    v_mov_b32 v147, 0
    v_mov_b32 v148, 0
    v_mov_b32 v149, 0
    v_mov_b32 v150, 0
    v_mov_b32 v151, 0
    v_mov_b32 v152, 0
    v_mov_b32 v153, 0
    v_mov_b32 v154, 0
    v_mov_b32 v155, 0
    v_mov_b32 v156, 0
    v_mov_b32 v157, 0
    v_mov_b32 v158, 0
    v_mov_b32 v159, 0
    v_mov_b32 v160, 0
    v_mov_b32 v161, 0
    v_mov_b32 v162, 0
    v_mov_b32 v163, 0
    v_mov_b32 v164, 0
    v_mov_b32 v165, 0
    v_mov_b32 v166, 0
    v_mov_b32 v167, 0
    v_mov_b32 v168, 0
    v_mov_b32 v169, 0
    v_mov_b32 v170, 0
    v_mov_b32 v171, 0
    v_mov_b32 v172, 0
    v_mov_b32 v173, 0
    v_mov_b32 v174, 0
    v_mov_b32 v175, 0
    v_mov_b32 v176, 0
    v_mov_b32 v177, 0
    v_mov_b32 v178, 0
    v_mov_b32 v179, 0
    v_mov_b32 v180, 0
    v_mov_b32 v181, 0
    v_mov_b32 v182, 0
    v_mov_b32 v183, 0
    v_mov_b32 v184, 0
    v_mov_b32 v185, 0
    v_mov_b32 v186, 0
    v_mov_b32 v187, 0
    v_mov_b32 v188, 0
    v_mov_b32 v189, 0
    v_mov_b32 v190, 0
    v_mov_b32 v191, 0
    v_mov_b32 v192, 0
    v_mov_b32 v193, 0
    v_mov_b32 v194, 0
    v_mov_b32 v195, 0
    v_mov_b32 v196, 0
    v_mov_b32 v197, 0
    v_mov_b32 v198, 0
    v_mov_b32 v199, 0
    v_mov_b32 v200, 0
    v_mov_b32 v201, 0
    v_mov_b32 v202, 0
    v_mov_b32 v203, 0
    v_mov_b32 v204, 0
    v_mov_b32 v205, 0
    v_mov_b32 v206, 0
    v_mov_b32 v207, 0
    v_mov_b32 v208, 0
    v_mov_b32 v209, 0
    v_mov_b32 v210, 0
    v_mov_b32 v211, 0
    v_mov_b32 v212, 0
    v_mov_b32 v213, 0
    v_mov_b32 v214, 0
    v_mov_b32 v215, 0
    v_mov_b32 v216, 0
    v_mov_b32 v217, 0
    v_mov_b32 v218, 0
    v_mov_b32 v219, 0
    v_mov_b32 v220, 0
    v_mov_b32 v221, 0
    v_mov_b32 v222, 0
    v_mov_b32 v223, 0
    v_mov_b32 v244, 0
    v_mov_b32 v245, 0
    v_mov_b32 v246, 0
    v_mov_b32 v247, 0
    v_mov_b32 v248, 0
    v_mov_b32 v249, 0
    v_mov_b32 v250, 0
    v_mov_b32 v251, 0
    v_mov_b32 v252, 0
    v_mov_b32 v253, 0
    v_mov_b32 v254, 0
    v_mov_b32 v255, 0
    v_mov_b32 v116, 0
    v_mov_b32 v117, 0
    v_mov_b32 v118, 0
    v_mov_b32 v119, 0
    v_mov_b32 v120, 0
    v_mov_b32 v121, 0
    v_mov_b32 v122, 0
    v_mov_b32 v123, 0
    s_mov_b32 s58, 0xc0135761
    s_mov_b32 s59, s58
    s_mov_b32 s60, 0xbdd2d3e8
    s_mov_b32 s61, s60
    s_mov_b32 s62, 1.0
    s_mov_b32 s63, 1.0
    s_lshl_b32 s28, s101, 1
    s_add_u32 s28, s28, s48
    s_mul_i32 s64, s28, 196608
    s_mul_i32 s29, s14, 6
    s_mul_i32 s65, s49, 3
    s_add_u32 s65, s65, s29
    s_lshl_b32 s28, s28, 2
    s_lshr_b32 s29, s14, 2
    s_add_u32 s28, s28, s29
    s_mul_i32 s28, s28, 256
    s_and_b32 s29, s14, 3
    s_lshl_b32 s29, s29, 3
    s_add_u32 s28, s28, s29
    s_lshl_b32 s29, s49, 2
    s_add_u32 s28, s28, s29
    s_add_u32 s73, s28, 14942208
    s_mul_i32 s56, s16, 245760
    s_mul_i32 s28, s3, 61440
    s_add_u32 s56, s56, s28
    s_add_u32 s56, s56, 6291456
    s_lshl_b32 s28, s15, 2
    s_add_u32 s28, s28, s3
    s_mul_i32 s28, s28, 2
    s_and_b32 s29, s16, 1
    s_add_u32 s28, s28, s29
    s_lshl_b32 s28, s28, 7
    s_add_u32 s74, s28, 14942208
    s_mul_i32 s67, s15, 196608
    s_mul_i32 s29, s3, 49152
    s_add_u32 s67, s67, s29
    s_lshl_b32 s28, s3, 5
    s_add_u32 s72, s100, s28
    s_mul_i32 s72, s72, 1280
    s_mul_i32 s75, s16, 160
    s_add_u32 s72, s72, s75
    s_waitcnt lgkmcnt(0)
    s_mul_i32 s12, s12, 0x9E3779B1
    s_add_u32 s12, s12, 0x7F4A7C15
    s_mov_b32 s13, s12
    s_waitcnt vmcnt(0)
    s_mov_b32 s46, 0
Lg1loop:
    s_waitcnt lgkmcnt(0)
    v_mfma_f32_32x32x16_bf16 v[128:143], v[244:247], v[116:119], v[128:143]
    v_add_u32 v108, s52, v108
    v_add_u32 v109, s52, v109
    v_add_u32 v110, s52, v110
    v_add_u32 v111, s52, v111
    v_add_u32 v112, s52, v112
    v_mfma_f32_32x32x16_bf16 v[176:191], v[244:247], v[120:123], v[176:191]
    s_barrier
    ds_read_b128 v[236:239], v108 offset:0
    ds_read_b64_tr_b16 v[224:225], v112 offset:0
    ds_read_b64_tr_b16 v[226:227], v112 offset:768
    ds_read_b128 v[240:243], v108 offset:8192
    v_mfma_f32_32x32x16_bf16 v[144:159], v[248:251], v[116:119], v[144:159]
    ds_read_b64_tr_b16 v[228:229], v112 offset:32
    ds_read_b64_tr_b16 v[230:231], v112 offset:800
    ds_read_b64_tr_b16 v[232:233], v112 offset:64
    ds_read_b64_tr_b16 v[234:235], v112 offset:832
    v_mfma_f32_32x32x16_bf16 v[192:207], v[248:251], v[120:123], v[192:207]
    v_mfma_f32_32x32x16_bf16 v[160:175], v[252:255], v[116:119], v[160:175]
    v_mfma_f32_32x32x16_bf16 v[208:223], v[252:255], v[120:123], v[208:223]
    s_waitcnt lgkmcnt(5)
    v_mfma_f32_32x32x16_bf16 v[128:143], v[224:227], v[236:239], v[128:143]
    ds_read_b128 v[116:119], v109 offset:0
    ds_read_b64_tr_b16 v[244:245], v112 offset:3072
    ds_read_b64_tr_b16 v[246:247], v112 offset:3840
    ds_read_b128 v[120:123], v109 offset:8192
    s_waitcnt lgkmcnt(8)
    v_mfma_f32_32x32x16_bf16 v[176:191], v[224:227], v[240:243], v[176:191]
    ds_read_b64_tr_b16 v[248:249], v112 offset:3104
    ds_read_b64_tr_b16 v[250:251], v112 offset:3872
    ds_read_b64_tr_b16 v[252:253], v112 offset:3136
    ds_read_b64_tr_b16 v[254:255], v112 offset:3904
    s_waitcnt lgkmcnt(10)
    v_mfma_f32_32x32x16_bf16 v[144:159], v[228:231], v[236:239], v[144:159]
    v_mfma_f32_32x32x16_bf16 v[192:207], v[228:231], v[240:243], v[192:207]
    s_waitcnt lgkmcnt(8)
    v_mfma_f32_32x32x16_bf16 v[160:175], v[232:235], v[236:239], v[160:175]
    v_mfma_f32_32x32x16_bf16 v[208:223], v[232:235], v[240:243], v[208:223]
    s_waitcnt lgkmcnt(5)
    v_mfma_f32_32x32x16_bf16 v[128:143], v[244:247], v[116:119], v[128:143]
    ds_read_b128 v[236:239], v110 offset:0
    ds_read_b64_tr_b16 v[224:225], v112 offset:6144
    ds_read_b64_tr_b16 v[226:227], v112 offset:6912
    ds_read_b128 v[240:243], v110 offset:8192
    s_waitcnt lgkmcnt(8)
    v_mfma_f32_32x32x16_bf16 v[176:191], v[244:247], v[120:123], v[176:191]
    ds_read_b64_tr_b16 v[228:229], v112 offset:6176
    ds_read_b64_tr_b16 v[230:231], v112 offset:6944
    ds_read_b64_tr_b16 v[232:233], v112 offset:6208
    ds_read_b64_tr_b16 v[234:235], v112 offset:6976
    s_waitcnt lgkmcnt(10)
    v_mfma_f32_32x32x16_bf16 v[144:159], v[248:251], v[116:119], v[144:159]
    v_mfma_f32_32x32x16_bf16 v[192:207], v[248:251], v[120:123], v[192:207]
    s_waitcnt lgkmcnt(8)
    v_mfma_f32_32x32x16_bf16 v[160:175], v[252:255], v[116:119], v[160:175]
    v_mfma_f32_32x32x16_bf16 v[208:223], v[252:255], v[120:123], v[208:223]
    s_waitcnt lgkmcnt(5)
    v_mfma_f32_32x32x16_bf16 v[128:143], v[224:227], v[236:239], v[128:143]
    ds_read_b128 v[116:119], v111 offset:0
    ds_read_b64_tr_b16 v[244:245], v112 offset:9216
    ds_read_b64_tr_b16 v[246:247], v112 offset:9984
    ds_read_b128 v[120:123], v111 offset:8192
    s_waitcnt lgkmcnt(8)
    v_mfma_f32_32x32x16_bf16 v[176:191], v[224:227], v[240:243], v[176:191]
    ds_read_b64_tr_b16 v[248:249], v112 offset:9248
    ds_read_b64_tr_b16 v[250:251], v112 offset:10016
    ds_read_b64_tr_b16 v[252:253], v112 offset:9280
    ds_read_b64_tr_b16 v[254:255], v112 offset:10048
    s_waitcnt lgkmcnt(10)
    v_mfma_f32_32x32x16_bf16 v[144:159], v[228:231], v[236:239], v[144:159]
    v_mfma_f32_32x32x16_bf16 v[192:207], v[228:231], v[240:243], v[192:207]
    s_waitcnt lgkmcnt(8)
    v_mfma_f32_32x32x16_bf16 v[160:175], v[232:235], v[236:239], v[160:175]
    s_add_u32 s47, s47, 1
    s_cmp_eq_u32 s47, 3
    s_cselect_b32 s52, -81984, s53
    s_cselect_b32 s47, 0, s47
    v_mfma_f32_32x32x16_bf16 v[208:223], v[232:235], v[240:243], v[208:223]
    s_add_u32 s46, s46, 1
    s_cmp_lt_u32 s46, 8
    s_cbranch_scc1 Lg1loop
    s_waitcnt lgkmcnt(0)
    v_mfma_f32_32x32x16_bf16 v[128:143], v[244:247], v[116:119], v[128:143]
    v_add_u32 v108, s52, v108
    v_add_u32 v109, s52, v109
    v_add_u32 v110, s52, v110
    v_add_u32 v111, s52, v111
    v_add_u32 v112, s52, v112
    v_mfma_f32_32x32x16_bf16 v[176:191], v[244:247], v[120:123], v[176:191]
    s_barrier
    ds_read_b128 v[236:239], v108 offset:0
    ds_read_b64_tr_b16 v[224:225], v112 offset:0
    ds_read_b64_tr_b16 v[226:227], v112 offset:768
    ds_read_b128 v[240:243], v108 offset:8192
    v_mfma_f32_32x32x16_bf16 v[144:159], v[248:251], v[116:119], v[144:159]
    ds_read_b64_tr_b16 v[228:229], v112 offset:32
    ds_read_b64_tr_b16 v[230:231], v112 offset:800
    ds_read_b64_tr_b16 v[232:233], v112 offset:64
    ds_read_b64_tr_b16 v[234:235], v112 offset:832
    v_mfma_f32_32x32x16_bf16 v[192:207], v[248:251], v[120:123], v[192:207]
    v_mfma_f32_32x32x16_bf16 v[160:175], v[252:255], v[116:119], v[160:175]
    v_mfma_f32_32x32x16_bf16 v[208:223], v[252:255], v[120:123], v[208:223]
    s_waitcnt lgkmcnt(5)
    v_mfma_f32_32x32x16_bf16 v[128:143], v[224:227], v[236:239], v[128:143]
    ds_read_b128 v[116:119], v109 offset:0
    ds_read_b64_tr_b16 v[244:245], v112 offset:3072
    ds_read_b64_tr_b16 v[246:247], v112 offset:3840
    ds_read_b128 v[120:123], v109 offset:8192
    s_waitcnt lgkmcnt(8)
    v_mfma_f32_32x32x16_bf16 v[176:191], v[224:227], v[240:243], v[176:191]
    ds_read_b64_tr_b16 v[248:249], v112 offset:3104
    ds_read_b64_tr_b16 v[250:251], v112 offset:3872
    ds_read_b64_tr_b16 v[252:253], v112 offset:3136
    ds_read_b64_tr_b16 v[254:255], v112 offset:3904
    s_waitcnt lgkmcnt(10)
    v_mfma_f32_32x32x16_bf16 v[144:159], v[228:231], v[236:239], v[144:159]
    v_mfma_f32_32x32x16_bf16 v[192:207], v[228:231], v[240:243], v[192:207]
    s_waitcnt lgkmcnt(8)
    v_mfma_f32_32x32x16_bf16 v[160:175], v[232:235], v[236:239], v[160:175]
    v_mfma_f32_32x32x16_bf16 v[208:223], v[232:235], v[240:243], v[208:223]
    s_waitcnt lgkmcnt(5)
    v_mfma_f32_32x32x16_bf16 v[128:143], v[244:247], v[116:119], v[128:143]
    ds_read_b128 v[236:239], v110 offset:0
    ds_read_b64_tr_b16 v[224:225], v112 offset:6144
    ds_read_b64_tr_b16 v[226:227], v112 offset:6912
    ds_read_b128 v[240:243], v110 offset:8192
    s_waitcnt lgkmcnt(8)
    v_mfma_f32_32x32x16_bf16 v[176:191], v[244:247], v[120:123], v[176:191]
    ds_read_b64_tr_b16 v[228:229], v112 offset:6176
    ds_read_b64_tr_b16 v[230:231], v112 offset:6944
    ds_read_b64_tr_b16 v[232:233], v112 offset:6208
    ds_read_b64_tr_b16 v[234:235], v112 offset:6976
    s_waitcnt lgkmcnt(10)
    v_mfma_f32_32x32x16_bf16 v[144:159], v[248:251], v[116:119], v[144:159]
    v_mfma_f32_32x32x16_bf16 v[192:207], v[248:251], v[120:123], v[192:207]
    s_waitcnt lgkmcnt(8)
    v_mfma_f32_32x32x16_bf16 v[160:175], v[252:255], v[116:119], v[160:175]
    v_mfma_f32_32x32x16_bf16 v[208:223], v[252:255], v[120:123], v[208:223]
    s_waitcnt lgkmcnt(5)
    v_mfma_f32_32x32x16_bf16 v[128:143], v[224:227], v[236:239], v[128:143]
    ds_read_b128 v[116:119], v111 offset:0
    ds_read_b64_tr_b16 v[244:245], v112 offset:9216
    ds_read_b64_tr_b16 v[246:247], v112 offset:9984
    ds_read_b128 v[120:123], v111 offset:8192
    s_waitcnt lgkmcnt(8)
    v_mfma_f32_32x32x16_bf16 v[176:191], v[224:227], v[240:243], v[176:191]
    ds_read_b64_tr_b16 v[248:249], v112 offset:9248
    ds_read_b64_tr_b16 v[250:251], v112 offset:10016
    ds_read_b64_tr_b16 v[252:253], v112 offset:9280
    ds_read_b64_tr_b16 v[254:255], v112 offset:10048
    ds_read_b32 v113, v3 offset:32
    s_waitcnt lgkmcnt(11)
    v_mfma_f32_32x32x16_bf16 v[144:159], v[228:231], v[236:239], v[144:159]
    v_mfma_f32_32x32x16_bf16 v[192:207], v[228:231], v[240:243], v[192:207]
    s_waitcnt lgkmcnt(9)
    v_mfma_f32_32x32x16_bf16 v[160:175], v[232:235], v[236:239], v[160:175]
    s_add_u32 s47, s47, 1
    s_cmp_eq_u32 s47, 3
    s_cselect_b32 s52, -81984, s53
    s_cselect_b32 s47, 0, s47
    v_mfma_f32_32x32x16_bf16 v[208:223], v[232:235], v[240:243], v[208:223]
    s_waitcnt lgkmcnt(0)
    v_mfma_f32_32x32x16_bf16 v[128:143], v[244:247], v[116:119], v[128:143]
    v_readfirstlane_b32 s50, v113
    v_add_u32 v108, s52, v108
    v_add_u32 v112, s52, v112
    s_cmp_gt_u32 s50, 9
    s_cbranch_scc0 Lslow_25
Lback_26:
    ds_read_b128 v[236:239], v108 offset:0
    ds_read_b64_tr_b16 v[224:225], v112 offset:0
    ds_read_b64_tr_b16 v[226:227], v112 offset:768
    v_mfma_f32_32x32x16_bf16 v[176:191], v[244:247], v[120:123], v[176:191]
    s_mov_b64 exec, 1
    ds_add_u32 v3, v2 offset:0
    s_mov_b64 exec, -1
    ds_read_b128 v[240:243], v108 offset:8192
    ds_read_b64_tr_b16 v[228:229], v112 offset:32
    ds_read_b64_tr_b16 v[230:231], v112 offset:800
    v_mfma_f32_32x32x16_bf16 v[144:159], v[248:251], v[116:119], v[144:159]
    ds_read_b64_tr_b16 v[232:233], v112 offset:64
    ds_read_b64_tr_b16 v[234:235], v112 offset:832
    v_add_u32 v109, s52, v109
    v_add_u32 v110, s52, v110
    v_add_u32 v111, s52, v111
    v_mfma_f32_32x32x16_bf16 v[192:207], v[248:251], v[120:123], v[192:207]
    v_mfma_f32_32x32x16_bf16 v[160:175], v[252:255], v[116:119], v[160:175]
    s_add_u32 s57, s98, 0
    s_cmp_ge_u32 s57, 12
    s_cselect_b32 s18, 12, 0
    s_sub_u32 s57, s57, s18
    s_mul_i32 s57, s57, 5120
    s_add_u32 s57, s57, s56
    buffer_load_dwordx4 v[8:11], v0, s[8:11], s57 offen offset:0 sc1
    v_mfma_f32_32x32x16_bf16 v[208:223], v[252:255], v[120:123], v[208:223]
    buffer_load_dwordx4 v[12:15], v0, s[8:11], s57 offen offset:1024 sc1
    s_waitcnt lgkmcnt(5)
    v_mfma_f32_32x32x16_bf16 v[128:143], v[224:227], v[236:239], v[128:143]
    ds_read_b128 v[116:119], v109 offset:0
    ds_read_b64_tr_b16 v[244:245], v112 offset:3072
    ds_read_b64_tr_b16 v[246:247], v112 offset:3840
    ds_read_b128 v[120:123], v109 offset:8192
    s_waitcnt lgkmcnt(8)
    v_mfma_f32_32x32x16_bf16 v[176:191], v[224:227], v[240:243], v[176:191]
    ds_read_b64_tr_b16 v[248:249], v112 offset:3104
    ds_read_b64_tr_b16 v[250:251], v112 offset:3872
    ds_read_b64_tr_b16 v[252:253], v112 offset:3136
    ds_read_b64_tr_b16 v[254:255], v112 offset:3904
    s_waitcnt lgkmcnt(10)
    v_mfma_f32_32x32x16_bf16 v[144:159], v[228:231], v[236:239], v[144:159]
    v_mfma_f32_32x32x16_bf16 v[192:207], v[228:231], v[240:243], v[192:207]
    buffer_load_dwordx4 v[16:19], v0, s[8:11], s57 offen offset:2048 sc1
    s_waitcnt lgkmcnt(8)
    v_mfma_f32_32x32x16_bf16 v[160:175], v[232:235], v[236:239], v[160:175]
    v_mfma_f32_32x32x16_bf16 v[208:223], v[232:235], v[240:243], v[208:223]
    buffer_load_dwordx4 v[20:23], v0, s[8:11], s57 offen offset:3072 sc1
    s_waitcnt lgkmcnt(5)
    v_mfma_f32_32x32x16_bf16 v[128:143], v[244:247], v[116:119], v[128:143]
    ds_read_b128 v[236:239], v110 offset:0
    ds_read_b64_tr_b16 v[224:225], v112 offset:6144
    ds_read_b64_tr_b16 v[226:227], v112 offset:6912
    ds_read_b128 v[240:243], v110 offset:8192
    s_waitcnt lgkmcnt(8)
    v_mfma_f32_32x32x16_bf16 v[176:191], v[244:247], v[120:123], v[176:191]
    ds_read_b64_tr_b16 v[228:229], v112 offset:6176
    ds_read_b64_tr_b16 v[230:231], v112 offset:6944
    ds_read_b64_tr_b16 v[232:233], v112 offset:6208
    ds_read_b64_tr_b16 v[234:235], v112 offset:6976
    s_waitcnt lgkmcnt(10)
    v_mfma_f32_32x32x16_bf16 v[144:159], v[248:251], v[116:119], v[144:159]
    v_mfma_f32_32x32x16_bf16 v[192:207], v[248:251], v[120:123], v[192:207]
    s_add_u32 s57, s57, 4096
    buffer_load_dwordx4 v[24:27], v0, s[8:11], s57 offen offset:0 sc1
    s_waitcnt lgkmcnt(8)
    v_mfma_f32_32x32x16_bf16 v[160:175], v[252:255], v[116:119], v[160:175]
    v_mfma_f32_32x32x16_bf16 v[208:223], v[252:255], v[120:123], v[208:223]
    s_add_u32 s57, s98, 1
    s_cmp_ge_u32 s57, 12
    s_cselect_b32 s18, 12, 0
    s_sub_u32 s57, s57, s18
    s_mul_i32 s57, s57, 5120
    s_add_u32 s57, s57, s56
    buffer_load_dwordx4 v[28:31], v0, s[8:11], s57 offen offset:0 sc1
    s_waitcnt lgkmcnt(5)
    v_mfma_f32_32x32x16_bf16 v[128:143], v[224:227], v[236:239], v[128:143]
    ds_read_b128 v[116:119], v111 offset:0
    ds_read_b64_tr_b16 v[244:245], v112 offset:9216
    ds_read_b64_tr_b16 v[246:247], v112 offset:9984
    ds_read_b128 v[120:123], v111 offset:8192
    s_waitcnt lgkmcnt(8)
    v_mfma_f32_32x32x16_bf16 v[176:191], v[224:227], v[240:243], v[176:191]
    ds_read_b64_tr_b16 v[248:249], v112 offset:9248
    ds_read_b64_tr_b16 v[250:251], v112 offset:10016
    ds_read_b64_tr_b16 v[252:253], v112 offset:9280
    ds_read_b64_tr_b16 v[254:255], v112 offset:10048
    s_waitcnt lgkmcnt(10)
    v_mfma_f32_32x32x16_bf16 v[144:159], v[228:231], v[236:239], v[144:159]
    v_mfma_f32_32x32x16_bf16 v[192:207], v[228:231], v[240:243], v[192:207]
    buffer_load_dwordx4 v[32:35], v0, s[8:11], s57 offen offset:1024 sc1
    s_waitcnt lgkmcnt(8)
    v_mfma_f32_32x32x16_bf16 v[160:175], v[232:235], v[236:239], v[160:175]
    s_add_u32 s47, s47, 1
    s_cmp_eq_u32 s47, 3
    s_cselect_b32 s52, -81984, s53
    s_cselect_b32 s47, 0, s47
    v_mfma_f32_32x32x16_bf16 v[208:223], v[232:235], v[240:243], v[208:223]
    buffer_load_dwordx4 v[36:39], v0, s[8:11], s57 offen offset:2048 sc1
    s_waitcnt lgkmcnt(0)
    s_mov_b64 exec, 1
    ds_add_u32 v3, v2 offset:4
    s_mov_b64 exec, -1
    v_mfma_f32_32x32x16_bf16 v[128:143], v[244:247], v[116:119], v[128:143]
    buffer_load_dwordx4 v[40:43], v0, s[8:11], s57 offen offset:3072 sc1
    v_mfma_f32_32x32x16_bf16 v[176:191], v[244:247], v[120:123], v[176:191]
    s_add_u32 s57, s57, 4096
    buffer_load_dwordx4 v[44:47], v0, s[8:11], s57 offen offset:0 sc1
    v_mfma_f32_32x32x16_bf16 v[144:159], v[248:251], v[116:119], v[144:159]
    s_add_u32 s57, s98, 3
    s_cmp_ge_u32 s57, 12
    s_cselect_b32 s18, 12, 0
    s_sub_u32 s57, s57, s18
    s_mul_i32 s57, s57, 5120
    s_add_u32 s57, s57, s56
    buffer_load_dwordx4 v[48:51], v0, s[8:11], s57 offen offset:0 sc1
    v_mfma_f32_32x32x16_bf16 v[192:207], v[248:251], v[120:123], v[192:207]
    buffer_load_dwordx4 v[52:55], v0, s[8:11], s57 offen offset:1024 sc1
    v_mfma_f32_32x32x16_bf16 v[160:175], v[252:255], v[116:119], v[160:175]
    buffer_load_dwordx4 v[56:59], v0, s[8:11], s57 offen offset:2048 sc1
    v_mfma_f32_32x32x16_bf16 v[208:223], v[252:255], v[120:123], v[208:223]
    buffer_load_dwordx4 v[60:63], v0, s[8:11], s57 offen offset:3072 sc1
    s_setprio 3
    v_mov_b32 v232, s58
    v_mov_b32 v233, s58
    s_add_u32 s28, s65, 0
    s_lshr_b32 s29, s28, 1
    s_lshl_b32 s29, s29, 12
    s_and_b32 s28, s28, 1
    s_lshl_b32 s28, s28, 9
    s_add_u32 s28, s28, s29
    s_add_u32 s66, s28, s64
    v_pk_mul_f32 v[224:225], v[128:129], v[128:129]
    v_pk_mul_f32 v[226:227], v[130:131], v[130:131]
    v_pk_mul_f32 v[228:229], v[132:133], v[132:133]
    v_pk_mul_f32 v[230:231], v[134:135], v[134:135]
    v_pk_fma_f32 v[224:225], v[224:225], s[60:61], v[232:233]
    v_pk_fma_f32 v[226:227], v[226:227], s[60:61], v[232:233]
    v_pk_fma_f32 v[228:229], v[228:229], s[60:61], v[232:233]
    v_pk_fma_f32 v[230:231], v[230:231], s[60:61], v[232:233]
    v_pk_mul_f32 v[224:225], v[224:225], v[128:129]
    v_pk_mul_f32 v[226:227], v[226:227], v[130:131]
    v_pk_mul_f32 v[228:229], v[228:229], v[132:133]
    v_pk_mul_f32 v[230:231], v[230:231], v[134:135]
    v_exp_f32 v224, v224
    v_exp_f32 v225, v225
    v_exp_f32 v226, v226
    v_exp_f32 v227, v227
    v_exp_f32 v228, v228
    v_exp_f32 v229, v229
    v_exp_f32 v230, v230
    v_exp_f32 v231, v231
    v_pk_mul_f32 v[128:129], v[128:129], v[136:137]
    v_pk_mul_f32 v[130:131], v[130:131], v[138:139]
    v_pk_mul_f32 v[132:133], v[132:133], v[140:141]
    v_pk_mul_f32 v[134:135], v[134:135], v[142:143]
    v_pk_add_f32 v[224:225], v[224:225], s[62:63]
    v_pk_add_f32 v[226:227], v[226:227], s[62:63]
    v_pk_add_f32 v[228:229], v[228:229], s[62:63]
    v_pk_add_f32 v[230:231], v[230:231], s[62:63]
    v_rcp_f32 v224, v224
    v_rcp_f32 v225, v225
    v_rcp_f32 v226, v226
    v_rcp_f32 v227, v227
    v_rcp_f32 v228, v228
    v_rcp_f32 v229, v229
    v_rcp_f32 v230, v230
    v_rcp_f32 v231, v231
    v_pk_mul_f32 v[128:129], v[128:129], v[224:225]
    v_pk_mul_f32 v[130:131], v[130:131], v[226:227]
    v_pk_mul_f32 v[132:133], v[132:133], v[228:229]
    v_pk_mul_f32 v[134:135], v[134:135], v[230:231]
    v_cvt_pk_bf16_f32 v244, v128, v129
    v_cvt_pk_bf16_f32 v245, v130, v131
    v_cvt_pk_bf16_f32 v246, v132, v133
    v_cvt_pk_bf16_f32 v247, v134, v135
    buffer_store_dwordx4 v[244:247], v5, s[8:11], s66 offen offset:0 sc1
    v_pk_mul_f32 v[224:225], v[176:177], v[176:177]
    v_pk_mul_f32 v[226:227], v[178:179], v[178:179]
    v_pk_mul_f32 v[228:229], v[180:181], v[180:181]
    v_pk_mul_f32 v[230:231], v[182:183], v[182:183]
    v_pk_fma_f32 v[224:225], v[224:225], s[60:61], v[232:233]
    v_pk_fma_f32 v[226:227], v[226:227], s[60:61], v[232:233]
    v_pk_fma_f32 v[228:229], v[228:229], s[60:61], v[232:233]
    v_pk_fma_f32 v[230:231], v[230:231], s[60:61], v[232:233]
    v_pk_mul_f32 v[224:225], v[224:225], v[176:177]
    v_pk_mul_f32 v[226:227], v[226:227], v[178:179]
    v_pk_mul_f32 v[228:229], v[228:229], v[180:181]
    v_pk_mul_f32 v[230:231], v[230:231], v[182:183]
    v_exp_f32 v224, v224
    v_exp_f32 v225, v225
    v_exp_f32 v226, v226
    v_exp_f32 v227, v227
    v_exp_f32 v228, v228
    v_exp_f32 v229, v229
    v_exp_f32 v230, v230
    v_exp_f32 v231, v231
    v_pk_mul_f32 v[176:177], v[176:177], v[184:185]
    v_pk_mul_f32 v[178:179], v[178:179], v[186:187]
    v_pk_mul_f32 v[180:181], v[180:181], v[188:189]
    v_pk_mul_f32 v[182:183], v[182:183], v[190:191]
    v_pk_add_f32 v[224:225], v[224:225], s[62:63]
    v_pk_add_f32 v[226:227], v[226:227], s[62:63]
    v_pk_add_f32 v[228:229], v[228:229], s[62:63]
    v_pk_add_f32 v[230:231], v[230:231], s[62:63]
    v_rcp_f32 v224, v224
    v_rcp_f32 v225, v225
    v_rcp_f32 v226, v226
    v_rcp_f32 v227, v227
    v_rcp_f32 v228, v228
    v_rcp_f32 v229, v229
    v_rcp_f32 v230, v230
    v_rcp_f32 v231, v231
    v_pk_mul_f32 v[176:177], v[176:177], v[224:225]
    v_pk_mul_f32 v[178:179], v[178:179], v[226:227]
    v_pk_mul_f32 v[180:181], v[180:181], v[228:229]
    v_pk_mul_f32 v[182:183], v[182:183], v[230:231]
    v_cvt_pk_bf16_f32 v248, v176, v177
    v_cvt_pk_bf16_f32 v249, v178, v179
    v_cvt_pk_bf16_f32 v250, v180, v181
    v_cvt_pk_bf16_f32 v251, v182, v183
    buffer_store_dwordx4 v[248:251], v5, s[8:11], s66 offen offset:2048 sc1
    s_add_u32 s28, s65, 1
    s_lshr_b32 s29, s28, 1
    s_lshl_b32 s29, s29, 12
    s_and_b32 s28, s28, 1
    s_lshl_b32 s28, s28, 9
    s_add_u32 s28, s28, s29
    s_add_u32 s66, s28, s64
    v_pk_mul_f32 v[224:225], v[144:145], v[144:145]
    v_pk_mul_f32 v[226:227], v[146:147], v[146:147]
    v_pk_mul_f32 v[228:229], v[148:149], v[148:149]
    v_pk_mul_f32 v[230:231], v[150:151], v[150:151]
    v_pk_fma_f32 v[224:225], v[224:225], s[60:61], v[232:233]
    v_pk_fma_f32 v[226:227], v[226:227], s[60:61], v[232:233]
    v_pk_fma_f32 v[228:229], v[228:229], s[60:61], v[232:233]
    v_pk_fma_f32 v[230:231], v[230:231], s[60:61], v[232:233]
    v_pk_mul_f32 v[224:225], v[224:225], v[144:145]
    v_pk_mul_f32 v[226:227], v[226:227], v[146:147]
    v_pk_mul_f32 v[228:229], v[228:229], v[148:149]
    v_pk_mul_f32 v[230:231], v[230:231], v[150:151]
    v_exp_f32 v224, v224
    v_exp_f32 v225, v225
    v_exp_f32 v226, v226
    v_exp_f32 v227, v227
    v_exp_f32 v228, v228
    v_exp_f32 v229, v229
    v_exp_f32 v230, v230
    v_exp_f32 v231, v231
    v_pk_mul_f32 v[144:145], v[144:145], v[152:153]
    v_pk_mul_f32 v[146:147], v[146:147], v[154:155]
    v_pk_mul_f32 v[148:149], v[148:149], v[156:157]
    v_pk_mul_f32 v[150:151], v[150:151], v[158:159]
    v_pk_add_f32 v[224:225], v[224:225], s[62:63]
    v_pk_add_f32 v[226:227], v[226:227], s[62:63]
    v_pk_add_f32 v[228:229], v[228:229], s[62:63]
    v_pk_add_f32 v[230:231], v[230:231], s[62:63]
    v_rcp_f32 v224, v224
    v_rcp_f32 v225, v225
    v_rcp_f32 v226, v226
    v_rcp_f32 v227, v227
    v_rcp_f32 v228, v228
    v_rcp_f32 v229, v229
    v_rcp_f32 v230, v230
    v_rcp_f32 v231, v231
    v_pk_mul_f32 v[144:145], v[144:145], v[224:225]
    v_pk_mul_f32 v[146:147], v[146:147], v[226:227]
    v_pk_mul_f32 v[148:149], v[148:149], v[228:229]
    v_pk_mul_f32 v[150:151], v[150:151], v[230:231]
    v_cvt_pk_bf16_f32 v244, v144, v145
    v_cvt_pk_bf16_f32 v245, v146, v147
    v_cvt_pk_bf16_f32 v246, v148, v149
    v_cvt_pk_bf16_f32 v247, v150, v151
    buffer_store_dwordx4 v[244:247], v5, s[8:11], s66 offen offset:0 sc1
    v_pk_mul_f32 v[224:225], v[192:193], v[192:193]
    v_pk_mul_f32 v[226:227], v[194:195], v[194:195]
    v_pk_mul_f32 v[228:229], v[196:197], v[196:197]
    v_pk_mul_f32 v[230:231], v[198:199], v[198:199]
    v_pk_fma_f32 v[224:225], v[224:225], s[60:61], v[232:233]
    v_pk_fma_f32 v[226:227], v[226:227], s[60:61], v[232:233]
    v_pk_fma_f32 v[228:229], v[228:229], s[60:61], v[232:233]
    v_pk_fma_f32 v[230:231], v[230:231], s[60:61], v[232:233]
    v_pk_mul_f32 v[224:225], v[224:225], v[192:193]
    v_pk_mul_f32 v[226:227], v[226:227], v[194:195]
    v_pk_mul_f32 v[228:229], v[228:229], v[196:197]
    v_pk_mul_f32 v[230:231], v[230:231], v[198:199]
    v_exp_f32 v224, v224
    v_exp_f32 v225, v225
    v_exp_f32 v226, v226
    v_exp_f32 v227, v227
    v_exp_f32 v228, v228
    v_exp_f32 v229, v229
    v_exp_f32 v230, v230
    v_exp_f32 v231, v231
    v_pk_mul_f32 v[192:193], v[192:193], v[200:201]
    v_pk_mul_f32 v[194:195], v[194:195], v[202:203]
    v_pk_mul_f32 v[196:197], v[196:197], v[204:205]
    v_pk_mul_f32 v[198:199], v[198:199], v[206:207]
    v_pk_add_f32 v[224:225], v[224:225], s[62:63]
    v_pk_add_f32 v[226:227], v[226:227], s[62:63]
    v_pk_add_f32 v[228:229], v[228:229], s[62:63]
    v_pk_add_f32 v[230:231], v[230:231], s[62:63]
    v_rcp_f32 v224, v224
    v_rcp_f32 v225, v225
    v_rcp_f32 v226, v226
    v_rcp_f32 v227, v227
    v_rcp_f32 v228, v228
    v_rcp_f32 v229, v229
    v_rcp_f32 v230, v230
    v_rcp_f32 v231, v231
    v_pk_mul_f32 v[192:193], v[192:193], v[224:225]
    v_pk_mul_f32 v[194:195], v[194:195], v[226:227]
    v_pk_mul_f32 v[196:197], v[196:197], v[228:229]
    v_pk_mul_f32 v[198:199], v[198:199], v[230:231]
    v_cvt_pk_bf16_f32 v248, v192, v193
    v_cvt_pk_bf16_f32 v249, v194, v195
    v_cvt_pk_bf16_f32 v250, v196, v197
    v_cvt_pk_bf16_f32 v251, v198, v199
    buffer_store_dwordx4 v[248:251], v5, s[8:11], s66 offen offset:2048 sc1
    s_add_u32 s28, s65, 2
    s_lshr_b32 s29, s28, 1
    s_lshl_b32 s29, s29, 12
    s_and_b32 s28, s28, 1
    s_lshl_b32 s28, s28, 9
    s_add_u32 s28, s28, s29
    s_add_u32 s66, s28, s64
    v_pk_mul_f32 v[224:225], v[160:161], v[160:161]
    v_pk_mul_f32 v[226:227], v[162:163], v[162:163]
    v_pk_mul_f32 v[228:229], v[164:165], v[164:165]
    v_pk_mul_f32 v[230:231], v[166:167], v[166:167]
    v_pk_fma_f32 v[224:225], v[224:225], s[60:61], v[232:233]
    v_pk_fma_f32 v[226:227], v[226:227], s[60:61], v[232:233]
    v_pk_fma_f32 v[228:229], v[228:229], s[60:61], v[232:233]
    v_pk_fma_f32 v[230:231], v[230:231], s[60:61], v[232:233]
    v_pk_mul_f32 v[224:225], v[224:225], v[160:161]
    v_pk_mul_f32 v[226:227], v[226:227], v[162:163]
    v_pk_mul_f32 v[228:229], v[228:229], v[164:165]
    v_pk_mul_f32 v[230:231], v[230:231], v[166:167]
    v_exp_f32 v224, v224
    v_exp_f32 v225, v225
    v_exp_f32 v226, v226
    v_exp_f32 v227, v227
    v_exp_f32 v228, v228
    v_exp_f32 v229, v229
    v_exp_f32 v230, v230
    v_exp_f32 v231, v231
    v_pk_mul_f32 v[160:161], v[160:161], v[168:169]
    v_pk_mul_f32 v[162:163], v[162:163], v[170:171]
    v_pk_mul_f32 v[164:165], v[164:165], v[172:173]
    v_pk_mul_f32 v[166:167], v[166:167], v[174:175]
    v_pk_add_f32 v[224:225], v[224:225], s[62:63]
    v_pk_add_f32 v[226:227], v[226:227], s[62:63]
    v_pk_add_f32 v[228:229], v[228:229], s[62:63]
    v_pk_add_f32 v[230:231], v[230:231], s[62:63]
    v_rcp_f32 v224, v224
    v_rcp_f32 v225, v225
    v_rcp_f32 v226, v226
    v_rcp_f32 v227, v227
    v_rcp_f32 v228, v228
    v_rcp_f32 v229, v229
    v_rcp_f32 v230, v230
    v_rcp_f32 v231, v231
    v_pk_mul_f32 v[160:161], v[160:161], v[224:225]
    v_pk_mul_f32 v[162:163], v[162:163], v[226:227]
    v_pk_mul_f32 v[164:165], v[164:165], v[228:229]
    v_pk_mul_f32 v[166:167], v[166:167], v[230:231]
    v_cvt_pk_bf16_f32 v244, v160, v161
    v_cvt_pk_bf16_f32 v245, v162, v163
    v_cvt_pk_bf16_f32 v246, v164, v165
    v_cvt_pk_bf16_f32 v247, v166, v167
    buffer_store_dwordx4 v[244:247], v5, s[8:11], s66 offen offset:0 sc1
    v_pk_mul_f32 v[224:225], v[208:209], v[208:209]
    v_pk_mul_f32 v[226:227], v[210:211], v[210:211]
    v_pk_mul_f32 v[228:229], v[212:213], v[212:213]
    v_pk_mul_f32 v[230:231], v[214:215], v[214:215]
    v_pk_fma_f32 v[224:225], v[224:225], s[60:61], v[232:233]
    v_pk_fma_f32 v[226:227], v[226:227], s[60:61], v[232:233]
    v_pk_fma_f32 v[228:229], v[228:229], s[60:61], v[232:233]
    v_pk_fma_f32 v[230:231], v[230:231], s[60:61], v[232:233]
    v_pk_mul_f32 v[224:225], v[224:225], v[208:209]
    v_pk_mul_f32 v[226:227], v[226:227], v[210:211]
    v_pk_mul_f32 v[228:229], v[228:229], v[212:213]
    v_pk_mul_f32 v[230:231], v[230:231], v[214:215]
    v_exp_f32 v224, v224
    v_exp_f32 v225, v225
    v_exp_f32 v226, v226
    v_exp_f32 v227, v227
    v_exp_f32 v228, v228
    v_exp_f32 v229, v229
    v_exp_f32 v230, v230
    v_exp_f32 v231, v231
    v_pk_mul_f32 v[208:209], v[208:209], v[216:217]
    v_pk_mul_f32 v[210:211], v[210:211], v[218:219]
    v_pk_mul_f32 v[212:213], v[212:213], v[220:221]
    v_pk_mul_f32 v[214:215], v[214:215], v[222:223]
    v_pk_add_f32 v[224:225], v[224:225], s[62:63]
    v_pk_add_f32 v[226:227], v[226:227], s[62:63]
    v_pk_add_f32 v[228:229], v[228:229], s[62:63]
    v_pk_add_f32 v[230:231], v[230:231], s[62:63]
    v_rcp_f32 v224, v224
    v_rcp_f32 v225, v225
    v_rcp_f32 v226, v226
    v_rcp_f32 v227, v227
    v_rcp_f32 v228, v228
    v_rcp_f32 v229, v229
    v_rcp_f32 v230, v230
    v_rcp_f32 v231, v231
    v_pk_mul_f32 v[208:209], v[208:209], v[224:225]
    v_pk_mul_f32 v[210:211], v[210:211], v[226:227]
    v_pk_mul_f32 v[212:213], v[212:213], v[228:229]
    v_pk_mul_f32 v[214:215], v[214:215], v[230:231]
    v_cvt_pk_bf16_f32 v248, v208, v209
    v_cvt_pk_bf16_f32 v249, v210, v211
    v_cvt_pk_bf16_f32 v250, v212, v213
    v_cvt_pk_bf16_f32 v251, v214, v215
    buffer_store_dwordx4 v[248:251], v5, s[8:11], s66 offen offset:2048 sc1
    s_mov_b64 exec, 1
    ds_add_u32 v3, v2 offset:64
    s_mov_b64 exec, -1
    s_add_u32 s57, s57, 4096
    buffer_load_dwordx4 v[64:67], v0, s[8:11], s57 offen offset:0 sc1
    s_add_u32 s57, s98, 4
    s_cmp_ge_u32 s57, 12
    s_cselect_b32 s18, 12, 0
    s_sub_u32 s57, s57, s18
    s_mul_i32 s57, s57, 5120
    s_add_u32 s57, s57, s56
    buffer_load_dwordx4 v[68:71], v0, s[8:11], s57 offen offset:0 sc1
    buffer_load_dwordx4 v[72:75], v0, s[8:11], s57 offen offset:1024 sc1
    buffer_load_dwordx4 v[76:79], v0, s[8:11], s57 offen offset:2048 sc1
    buffer_load_dwordx4 v[80:83], v0, s[8:11], s57 offen offset:3072 sc1
    s_add_u32 s57, s57, 4096
    buffer_load_dwordx4 v[84:87], v0, s[8:11], s57 offen offset:0 sc1
    s_waitcnt vmcnt(6)
    v_mov_b32 v6, s12
    v_lshlrev_b32 v7, 7, v1
    s_mov_b64 exec, 3
    buffer_store_dword v6, v7, s[8:11], s73 offen sc1
    s_mov_b64 exec, -1
    s_setprio 1
    v_and_b32 v6, 7, v1
    v_lshlrev_b32 v6, 2, v6
    s_add_u32 s28, s3, 1
    s_and_b32 s28, s28, 3
    s_lshl_b32 s28, s28, 10
    v_add_u32 v172, s28, v0
    s_add_u32 s28, s3, 2
    s_and_b32 s28, s28, 3
    s_lshl_b32 s28, s28, 10
    v_add_u32 v173, s28, v0
    s_add_u32 s28, s3, 3
    s_and_b32 s28, s28, 3
    s_lshl_b32 s28, s28, 10
    v_add_u32 v174, s28, v0
    s_add_u32 s28, s3, 4
    s_and_b32 s28, s28, 3
    s_lshl_b32 s28, s28, 10
    v_add_u32 v175, s28, v0
    s_mov_b32 s40, 0x3f80
    s_mov_b32 s41, 0x3f800000
    s_mov_b32 s30, 0
Ls_27:
    s_load_dwordx8 s[20:27], s[8:9], s74 offset:0 glc
    s_waitcnt lgkmcnt(0)
    s_xor_b64 s[20:21], s[20:21], s[12:13]
    s_xor_b64 s[22:23], s[22:23], s[12:13]
    s_xor_b64 s[24:25], s[24:25], s[12:13]
    s_xor_b64 s[26:27], s[26:27], s[12:13]
    s_or_b64 s[20:21], s[20:21], s[22:23]
    s_or_b64 s[24:25], s[24:25], s[26:27]
    s_or_b64 s[20:21], s[20:21], s[24:25]
    s_cbranch_scc0 Lsd_28
    s_sleep 2
    s_add_u32 s30, s30, 1
    s_cmp_lt_u32 s30, 256
    s_cbranch_scc1 Ls_27
    s_mov_b32 s30, 0
Lf_29:
    buffer_load_dword v7, v6, s[8:11], s74 offen sc1
    s_waitcnt vmcnt(0)
    v_cmp_ne_u32 vcc, s12, v7
    s_cbranch_vccz Lfd_30
    s_sleep 1
    s_add_u32 s30, s30, 1
    s_cmp_lt_u32 s30, 16384
    s_cbranch_scc1 Lf_29
Lfd_30:
Lsd_28:
    s_add_u32 s78, s98, 0
    s_cmp_ge_u32 s78, 12
    s_cselect_b32 s18, 12, 0
    s_sub_u32 s78, s78, s18
    s_mul_i32 s78, s78, 4096
    s_add_u32 s78, s78, s67
    buffer_load_dwordx4 v[124:127], v172, s[8:11], s78 offen sc1
    buffer_load_dwordx4 v[128:131], v173, s[8:11], s78 offen sc1
    buffer_load_dwordx4 v[132:135], v174, s[8:11], s78 offen sc1
    buffer_load_dwordx4 v[136:139], v175, s[8:11], s78 offen sc1
    s_add_u32 s78, s98, 1
    s_cmp_ge_u32 s78, 12
    s_cselect_b32 s18, 12, 0
    s_sub_u32 s78, s78, s18
    s_mul_i32 s78, s78, 4096
    s_add_u32 s78, s78, s67
    buffer_load_dwordx4 v[140:143], v172, s[8:11], s78 offen sc1
    buffer_load_dwordx4 v[144:147], v173, s[8:11], s78 offen sc1
    buffer_load_dwordx4 v[148:151], v174, s[8:11], s78 offen sc1
    buffer_load_dwordx4 v[152:155], v175, s[8:11], s78 offen sc1
    s_add_u32 s78, s98, 3
    s_cmp_ge_u32 s78, 12
    s_cselect_b32 s18, 12, 0
    s_sub_u32 s78, s78, s18
    s_mul_i32 s78, s78, 4096
    s_add_u32 s78, s78, s67
    buffer_load_dwordx4 v[156:159], v172, s[8:11], s78 offen sc1
    buffer_load_dwordx4 v[160:163], v173, s[8:11], s78 offen sc1
    buffer_load_dwordx4 v[164:167], v174, s[8:11], s78 offen sc1
    buffer_load_dwordx4 v[168:171], v175, s[8:11], s78 offen sc1
    s_add_u32 s78, s98, 4
    s_cmp_ge_u32 s78, 12
    s_cselect_b32 s18, 12, 0
    s_sub_u32 s78, s78, s18
    s_mul_i32 s78, s78, 4096
    s_add_u32 s78, s78, s67
    buffer_load_dwordx4 v[108:111], v172, s[8:11], s78 offen sc1
    buffer_load_dwordx4 v[112:115], v173, s[8:11], s78 offen sc1
    buffer_load_dwordx4 v[116:119], v174, s[8:11], s78 offen sc1
    buffer_load_dwordx4 v[120:123], v175, s[8:11], s78 offen sc1
    s_add_u32 s78, s98, 6
    s_cmp_ge_u32 s78, 12
    s_cselect_b32 s18, 12, 0
    s_sub_u32 s78, s78, s18
    s_mul_i32 s78, s78, 4096
    s_add_u32 s78, s78, s67
    buffer_load_dwordx4 v[88:91], v172, s[8:11], s78 offen sc1
    buffer_load_dwordx4 v[92:95], v173, s[8:11], s78 offen sc1
    buffer_load_dwordx4 v[96:99], v174, s[8:11], s78 offen sc1
    buffer_load_dwordx4 v[100:103], v175, s[8:11], s78 offen sc1
    s_mul_i32 s28, s3, 5120
    v_add_u32 v6, s28, v0
    v_add_u32 v5, 61472, v6
    s_mov_b32 s31, 0
    s_setprio 3
    s_waitcnt lgkmcnt(0)
    s_waitcnt vmcnt(19)
    v_mfma_f32_16x16x32_bf16 v[176:179], v[8:11], v[124:127], 0
    v_mfma_f32_16x16x32_bf16 v[180:183], v[12:15], v[124:127], 0
    v_mfma_f32_16x16x32_bf16 v[184:187], v[16:19], v[124:127], 0
    v_mfma_f32_16x16x32_bf16 v[188:191], v[20:23], v[124:127], 0
    v_mfma_f32_16x16x32_bf16 v[192:195], v[24:27], v[124:127], 0
    s_add_u32 s78, s98, 7
    s_cmp_ge_u32 s78, 12
    s_cselect_b32 s18, 12, 0
    s_sub_u32 s78, s78, s18
    s_mul_i32 s78, s78, 4096
    s_add_u32 s78, s78, s67
    buffer_load_dwordx4 v[124:127], v172, s[8:11], s78 offen sc1
    s_waitcnt vmcnt(19)
    v_mfma_f32_16x16x32_bf16 v[196:199], v[8:11], v[128:131], 0
    v_mfma_f32_16x16x32_bf16 v[200:203], v[12:15], v[128:131], 0
    v_mfma_f32_16x16x32_bf16 v[204:207], v[16:19], v[128:131], 0
    v_mfma_f32_16x16x32_bf16 v[208:211], v[20:23], v[128:131], 0
    v_mfma_f32_16x16x32_bf16 v[212:215], v[24:27], v[128:131], 0
    buffer_load_dwordx4 v[128:131], v173, s[8:11], s78 offen sc1
    s_waitcnt vmcnt(19)
    v_mfma_f32_16x16x32_bf16 v[216:219], v[8:11], v[132:135], 0
    v_mfma_f32_16x16x32_bf16 v[220:223], v[12:15], v[132:135], 0
    v_mfma_f32_16x16x32_bf16 v[224:227], v[16:19], v[132:135], 0
    v_mfma_f32_16x16x32_bf16 v[228:231], v[20:23], v[132:135], 0
    v_mfma_f32_16x16x32_bf16 v[232:235], v[24:27], v[132:135], 0
    buffer_load_dwordx4 v[132:135], v174, s[8:11], s78 offen sc1
    s_waitcnt vmcnt(19)
    v_mfma_f32_16x16x32_bf16 v[236:239], v[8:11], v[136:139], 0
    v_mfma_f32_16x16x32_bf16 v[240:243], v[12:15], v[136:139], 0
    v_mfma_f32_16x16x32_bf16 v[244:247], v[16:19], v[136:139], 0
    v_mfma_f32_16x16x32_bf16 v[248:251], v[20:23], v[136:139], 0
    v_mfma_f32_16x16x32_bf16 v[252:255], v[24:27], v[136:139], 0
    buffer_load_dwordx4 v[136:139], v175, s[8:11], s78 offen sc1
    s_waitcnt lgkmcnt(0)
    s_waitcnt vmcnt(19)
    v_mfma_f32_16x16x32_bf16 v[176:179], v[28:31], v[140:143], v[176:179]
    s_add_u32 s57, s98, 11
    s_cmp_ge_u32 s57, 12
    s_cselect_b32 s18, 12, 0
    s_sub_u32 s57, s57, s18
    s_mul_i32 s57, s57, 5120
    s_add_u32 s57, s57, s56
    buffer_load_dwordx4 v[8:11], v0, s[8:11], s57 offen offset:0 sc1
    v_mfma_f32_16x16x32_bf16 v[180:183], v[32:35], v[140:143], v[180:183]
    buffer_load_dwordx4 v[12:15], v0, s[8:11], s57 offen offset:1024 sc1
    v_mfma_f32_16x16x32_bf16 v[184:187], v[36:39], v[140:143], v[184:187]
    buffer_load_dwordx4 v[16:19], v0, s[8:11], s57 offen offset:2048 sc1
    v_mfma_f32_16x16x32_bf16 v[188:191], v[40:43], v[140:143], v[188:191]
    buffer_load_dwordx4 v[20:23], v0, s[8:11], s57 offen offset:3072 sc1
    v_mfma_f32_16x16x32_bf16 v[192:195], v[44:47], v[140:143], v[192:195]
    s_add_u32 s57, s57, 4096
    buffer_load_dwordx4 v[24:27], v0, s[8:11], s57 offen offset:0 sc1
    s_add_u32 s78, s98, 9
    s_cmp_ge_u32 s78, 12
    s_cselect_b32 s18, 12, 0
    s_sub_u32 s78, s78, s18
    s_mul_i32 s78, s78, 4096
    s_add_u32 s78, s78, s67
    buffer_load_dwordx4 v[140:143], v172, s[8:11], s78 offen sc1
    s_waitcnt vmcnt(24)
    v_mfma_f32_16x16x32_bf16 v[196:199], v[28:31], v[144:147], v[196:199]
    v_mfma_f32_16x16x32_bf16 v[200:203], v[32:35], v[144:147], v[200:203]
    v_mfma_f32_16x16x32_bf16 v[204:207], v[36:39], v[144:147], v[204:207]
    v_mfma_f32_16x16x32_bf16 v[208:211], v[40:43], v[144:147], v[208:211]
    v_mfma_f32_16x16x32_bf16 v[212:215], v[44:47], v[144:147], v[212:215]
    buffer_load_dwordx4 v[144:147], v173, s[8:11], s78 offen sc1
    s_waitcnt vmcnt(24)
    v_mfma_f32_16x16x32_bf16 v[216:219], v[28:31], v[148:151], v[216:219]
    v_mfma_f32_16x16x32_bf16 v[220:223], v[32:35], v[148:151], v[220:223]
    v_mfma_f32_16x16x32_bf16 v[224:227], v[36:39], v[148:151], v[224:227]
    v_mfma_f32_16x16x32_bf16 v[228:231], v[40:43], v[148:151], v[228:231]
    v_mfma_f32_16x16x32_bf16 v[232:235], v[44:47], v[148:151], v[232:235]
    buffer_load_dwordx4 v[148:151], v174, s[8:11], s78 offen sc1
    s_waitcnt vmcnt(24)
    v_mfma_f32_16x16x32_bf16 v[236:239], v[28:31], v[152:155], v[236:239]
    v_mfma_f32_16x16x32_bf16 v[240:243], v[32:35], v[152:155], v[240:243]
    v_mfma_f32_16x16x32_bf16 v[244:247], v[36:39], v[152:155], v[244:247]
    v_mfma_f32_16x16x32_bf16 v[248:251], v[40:43], v[152:155], v[248:251]
    v_mfma_f32_16x16x32_bf16 v[252:255], v[44:47], v[152:155], v[252:255]
    buffer_load_dwordx4 v[152:155], v175, s[8:11], s78 offen sc1
    s_setprio 1
    s_waitcnt lgkmcnt(0)
    s_waitcnt vmcnt(24)
    v_mfma_f32_16x16x32_bf16 v[176:179], v[48:51], v[156:159], v[176:179]
    v_mfma_f32_16x16x32_bf16 v[180:183], v[52:55], v[156:159], v[180:183]
    v_mfma_f32_16x16x32_bf16 v[184:187], v[56:59], v[156:159], v[184:187]
    v_mfma_f32_16x16x32_bf16 v[188:191], v[60:63], v[156:159], v[188:191]
    v_mfma_f32_16x16x32_bf16 v[192:195], v[64:67], v[156:159], v[192:195]
    s_add_u32 s78, s98, 10
    s_cmp_ge_u32 s78, 12
    s_cselect_b32 s18, 12, 0
    s_sub_u32 s78, s78, s18
    s_mul_i32 s78, s78, 4096
    s_add_u32 s78, s78, s67
    buffer_load_dwordx4 v[156:159], v172, s[8:11], s78 offen sc1
    s_waitcnt vmcnt(24)
    v_mfma_f32_16x16x32_bf16 v[196:199], v[48:51], v[160:163], v[196:199]
    v_mfma_f32_16x16x32_bf16 v[200:203], v[52:55], v[160:163], v[200:203]
    v_mfma_f32_16x16x32_bf16 v[204:207], v[56:59], v[160:163], v[204:207]
    v_mfma_f32_16x16x32_bf16 v[208:211], v[60:63], v[160:163], v[208:211]
    v_mfma_f32_16x16x32_bf16 v[212:215], v[64:67], v[160:163], v[212:215]
    buffer_load_dwordx4 v[160:163], v173, s[8:11], s78 offen sc1
    s_waitcnt vmcnt(24)
    v_mfma_f32_16x16x32_bf16 v[216:219], v[48:51], v[164:167], v[216:219]
    v_mfma_f32_16x16x32_bf16 v[220:223], v[52:55], v[164:167], v[220:223]
    v_mfma_f32_16x16x32_bf16 v[224:227], v[56:59], v[164:167], v[224:227]
    v_mfma_f32_16x16x32_bf16 v[228:231], v[60:63], v[164:167], v[228:231]
    v_mfma_f32_16x16x32_bf16 v[232:235], v[64:67], v[164:167], v[232:235]
    buffer_load_dwordx4 v[164:167], v174, s[8:11], s78 offen sc1
    s_waitcnt vmcnt(24)
    v_mfma_f32_16x16x32_bf16 v[236:239], v[48:51], v[168:171], v[236:239]
    v_mfma_f32_16x16x32_bf16 v[240:243], v[52:55], v[168:171], v[240:243]
    v_mfma_f32_16x16x32_bf16 v[244:247], v[56:59], v[168:171], v[244:247]
    v_mfma_f32_16x16x32_bf16 v[248:251], v[60:63], v[168:171], v[248:251]
    v_mfma_f32_16x16x32_bf16 v[252:255], v[64:67], v[168:171], v[252:255]
    buffer_load_dwordx4 v[168:171], v175, s[8:11], s78 offen sc1
    s_waitcnt lgkmcnt(0)
    s_cmp_ge_u32 s31, 1
    s_cbranch_scc1 Lwg_31
    s_mov_b32 s30, 0
Lp_32:
    ds_read_b32 v4, v3 offset:40
    s_waitcnt lgkmcnt(0)
    v_readfirstlane_b32 s31, v4
    s_cmp_ge_u32 s31, 1
    s_cbranch_scc1 Lpd_33
    s_add_u32 s30, s30, 1
    s_cmp_lt_u32 s30, 262144
    s_cbranch_scc1 Lp_32
Lpd_33:
Lwg_31:
    s_waitcnt vmcnt(24)
    v_mfma_f32_16x16x32_bf16 v[176:179], v[68:71], v[108:111], v[176:179]
    ds_read_b128 v[28:31], v5 offset:20512
    v_mfma_f32_16x16x32_bf16 v[180:183], v[72:75], v[108:111], v[180:183]
    ds_read_b128 v[32:35], v5 offset:21536
    v_mfma_f32_16x16x32_bf16 v[184:187], v[76:79], v[108:111], v[184:187]
    ds_read_b128 v[36:39], v5 offset:22560
    v_mfma_f32_16x16x32_bf16 v[188:191], v[80:83], v[108:111], v[188:191]
    ds_read_b128 v[40:43], v5 offset:23584
    v_mfma_f32_16x16x32_bf16 v[192:195], v[84:87], v[108:111], v[192:195]
    ds_read_b128 v[44:47], v5 offset:24608
    s_add_u32 s78, s98, 2
    s_cmp_ge_u32 s78, 12
    s_cselect_b32 s18, 12, 0
    s_sub_u32 s78, s78, s18
    s_mul_i32 s78, s78, 4096
    s_add_u32 s78, s78, s67
    buffer_load_dwordx4 v[108:111], v172, s[8:11], s78 offen sc1
    s_waitcnt vmcnt(24)
    v_mfma_f32_16x16x32_bf16 v[196:199], v[68:71], v[112:115], v[196:199]
    v_mfma_f32_16x16x32_bf16 v[200:203], v[72:75], v[112:115], v[200:203]
    v_mfma_f32_16x16x32_bf16 v[204:207], v[76:79], v[112:115], v[204:207]
    v_mfma_f32_16x16x32_bf16 v[208:211], v[80:83], v[112:115], v[208:211]
    v_mfma_f32_16x16x32_bf16 v[212:215], v[84:87], v[112:115], v[212:215]
    buffer_load_dwordx4 v[112:115], v173, s[8:11], s78 offen sc1
    s_waitcnt vmcnt(24)
    v_mfma_f32_16x16x32_bf16 v[216:219], v[68:71], v[116:119], v[216:219]
    v_mfma_f32_16x16x32_bf16 v[220:223], v[72:75], v[116:119], v[220:223]
    v_mfma_f32_16x16x32_bf16 v[224:227], v[76:79], v[116:119], v[224:227]
    v_mfma_f32_16x16x32_bf16 v[228:231], v[80:83], v[116:119], v[228:231]
    v_mfma_f32_16x16x32_bf16 v[232:235], v[84:87], v[116:119], v[232:235]
    buffer_load_dwordx4 v[116:119], v174, s[8:11], s78 offen sc1
    s_waitcnt vmcnt(24)
    v_mfma_f32_16x16x32_bf16 v[236:239], v[68:71], v[120:123], v[236:239]
    v_mfma_f32_16x16x32_bf16 v[240:243], v[72:75], v[120:123], v[240:243]
    v_mfma_f32_16x16x32_bf16 v[244:247], v[76:79], v[120:123], v[244:247]
    v_mfma_f32_16x16x32_bf16 v[248:251], v[80:83], v[120:123], v[248:251]
    v_mfma_f32_16x16x32_bf16 v[252:255], v[84:87], v[120:123], v[252:255]
    buffer_load_dwordx4 v[120:123], v175, s[8:11], s78 offen sc1
    s_waitcnt lgkmcnt(0)
    s_cmp_ge_u32 s31, 2
    s_cbranch_scc1 Lwg_34
    s_mov_b32 s30, 0
Lp_35:
    ds_read_b32 v4, v3 offset:40
    s_waitcnt lgkmcnt(0)
    v_readfirstlane_b32 s31, v4
    s_cmp_ge_u32 s31, 2
    s_cbranch_scc1 Lpd_36
    s_add_u32 s30, s30, 1
    s_cmp_lt_u32 s30, 262144
    s_cbranch_scc1 Lp_35
Lpd_36:
Lwg_34:
    s_waitcnt vmcnt(24)
    v_mfma_f32_16x16x32_bf16 v[176:179], v[28:31], v[88:91], v[176:179]
    ds_read_b128 v[48:51], v5 offset:40992
    v_mfma_f32_16x16x32_bf16 v[180:183], v[32:35], v[88:91], v[180:183]
    ds_read_b128 v[52:55], v5 offset:42016
    v_mfma_f32_16x16x32_bf16 v[184:187], v[36:39], v[88:91], v[184:187]
    ds_read_b128 v[56:59], v5 offset:43040
    v_mfma_f32_16x16x32_bf16 v[188:191], v[40:43], v[88:91], v[188:191]
    ds_read_b128 v[60:63], v5 offset:44064
    v_mfma_f32_16x16x32_bf16 v[192:195], v[44:47], v[88:91], v[192:195]
    ds_read_b128 v[64:67], v5 offset:45088
    s_add_u32 s57, s98, 2
    s_cmp_ge_u32 s57, 12
    s_cselect_b32 s18, 12, 0
    s_sub_u32 s57, s57, s18
    s_mul_i32 s57, s57, 5120
    s_add_u32 s57, s57, s56
    buffer_load_dwordx4 v[88:91], v0, s[8:11], s57 offen offset:0 sc1
    s_waitcnt vmcnt(24)
    v_mfma_f32_16x16x32_bf16 v[196:199], v[28:31], v[92:95], v[196:199]
    v_mfma_f32_16x16x32_bf16 v[200:203], v[32:35], v[92:95], v[200:203]
    v_mfma_f32_16x16x32_bf16 v[204:207], v[36:39], v[92:95], v[204:207]
    v_mfma_f32_16x16x32_bf16 v[208:211], v[40:43], v[92:95], v[208:211]
    v_mfma_f32_16x16x32_bf16 v[212:215], v[44:47], v[92:95], v[212:215]
    buffer_load_dwordx4 v[92:95], v0, s[8:11], s57 offen offset:1024 sc1
    s_waitcnt vmcnt(24)
    v_mfma_f32_16x16x32_bf16 v[216:219], v[28:31], v[96:99], v[216:219]
    v_mfma_f32_16x16x32_bf16 v[220:223], v[32:35], v[96:99], v[220:223]
    v_mfma_f32_16x16x32_bf16 v[224:227], v[36:39], v[96:99], v[224:227]
    v_mfma_f32_16x16x32_bf16 v[228:231], v[40:43], v[96:99], v[228:231]
    v_mfma_f32_16x16x32_bf16 v[232:235], v[44:47], v[96:99], v[232:235]
    buffer_load_dwordx4 v[96:99], v0, s[8:11], s57 offen offset:2048 sc1
    s_waitcnt vmcnt(24)
    v_mfma_f32_16x16x32_bf16 v[236:239], v[28:31], v[100:103], v[236:239]
    v_mfma_f32_16x16x32_bf16 v[240:243], v[32:35], v[100:103], v[240:243]
    v_mfma_f32_16x16x32_bf16 v[244:247], v[36:39], v[100:103], v[244:247]
    v_mfma_f32_16x16x32_bf16 v[248:251], v[40:43], v[100:103], v[248:251]
    v_mfma_f32_16x16x32_bf16 v[252:255], v[44:47], v[100:103], v[252:255]
    buffer_load_dwordx4 v[100:103], v0, s[8:11], s57 offen offset:3072 sc1
    s_add_u32 s57, s57, 4096
    buffer_load_dwordx4 v[104:107], v0, s[8:11], s57 offen offset:0 sc1
    s_waitcnt lgkmcnt(0)
    s_cmp_ge_u32 s31, 3
    s_cbranch_scc1 Lwg_37
    s_mov_b32 s30, 0
Lp_38:
    ds_read_b32 v4, v3 offset:40
    s_waitcnt lgkmcnt(0)
    v_readfirstlane_b32 s31, v4
    s_cmp_ge_u32 s31, 3
    s_cbranch_scc1 Lpd_39
    s_add_u32 s30, s30, 1
    s_cmp_lt_u32 s30, 262144
    s_cbranch_scc1 Lp_38
Lpd_39:
Lwg_37:
    s_waitcnt vmcnt(25)
    v_mfma_f32_16x16x32_bf16 v[176:179], v[48:51], v[124:127], v[176:179]
    ds_read_b128 v[68:71], v6 offset:0
    v_mfma_f32_16x16x32_bf16 v[180:183], v[52:55], v[124:127], v[180:183]
    ds_read_b128 v[72:75], v6 offset:1024
    v_mfma_f32_16x16x32_bf16 v[184:187], v[56:59], v[124:127], v[184:187]
    ds_read_b128 v[76:79], v6 offset:2048
    v_mfma_f32_16x16x32_bf16 v[188:191], v[60:63], v[124:127], v[188:191]
    ds_read_b128 v[80:83], v6 offset:3072
    v_mfma_f32_16x16x32_bf16 v[192:195], v[64:67], v[124:127], v[192:195]
    ds_read_b128 v[84:87], v6 offset:4096
    s_add_u32 s78, s98, 5
    s_cmp_ge_u32 s78, 12
    s_cselect_b32 s18, 12, 0
    s_sub_u32 s78, s78, s18
    s_mul_i32 s78, s78, 4096
    s_add_u32 s78, s78, s67
    buffer_load_dwordx4 v[124:127], v172, s[8:11], s78 offen sc1
    s_waitcnt vmcnt(25)
    v_mfma_f32_16x16x32_bf16 v[196:199], v[48:51], v[128:131], v[196:199]
    v_mfma_f32_16x16x32_bf16 v[200:203], v[52:55], v[128:131], v[200:203]
    v_mfma_f32_16x16x32_bf16 v[204:207], v[56:59], v[128:131], v[204:207]
    v_mfma_f32_16x16x32_bf16 v[208:211], v[60:63], v[128:131], v[208:211]
    v_mfma_f32_16x16x32_bf16 v[212:215], v[64:67], v[128:131], v[212:215]
    buffer_load_dwordx4 v[128:131], v173, s[8:11], s78 offen sc1
    s_waitcnt vmcnt(25)
    v_mfma_f32_16x16x32_bf16 v[216:219], v[48:51], v[132:135], v[216:219]
    v_mfma_f32_16x16x32_bf16 v[220:223], v[52:55], v[132:135], v[220:223]
    v_mfma_f32_16x16x32_bf16 v[224:227], v[56:59], v[132:135], v[224:227]
    v_mfma_f32_16x16x32_bf16 v[228:231], v[60:63], v[132:135], v[228:231]
    v_mfma_f32_16x16x32_bf16 v[232:235], v[64:67], v[132:135], v[232:235]
    buffer_load_dwordx4 v[132:135], v174, s[8:11], s78 offen sc1
    s_waitcnt vmcnt(25)
    v_mfma_f32_16x16x32_bf16 v[236:239], v[48:51], v[136:139], v[236:239]
    v_mfma_f32_16x16x32_bf16 v[240:243], v[52:55], v[136:139], v[240:243]
    v_mfma_f32_16x16x32_bf16 v[244:247], v[56:59], v[136:139], v[244:247]
    v_mfma_f32_16x16x32_bf16 v[248:251], v[60:63], v[136:139], v[248:251]
    v_mfma_f32_16x16x32_bf16 v[252:255], v[64:67], v[136:139], v[252:255]
    buffer_load_dwordx4 v[136:139], v175, s[8:11], s78 offen sc1
    s_waitcnt lgkmcnt(0)
    s_cmp_ge_u32 s31, 4
    s_cbranch_scc1 Lwg_40
    s_mov_b32 s30, 0
Lp_41:
    ds_read_b32 v4, v3 offset:40
    s_waitcnt lgkmcnt(0)
    v_readfirstlane_b32 s31, v4
    s_cmp_ge_u32 s31, 4
    s_cbranch_scc1 Lpd_42
    s_add_u32 s30, s30, 1
    s_cmp_lt_u32 s30, 262144
    s_cbranch_scc1 Lp_41
Lpd_42:
Lwg_40:
    s_waitcnt vmcnt(20)
    v_mfma_f32_16x16x32_bf16 v[176:179], v[68:71], v[140:143], v[176:179]
    ds_read_b128 v[28:31], v6 offset:20480
    v_mfma_f32_16x16x32_bf16 v[180:183], v[72:75], v[140:143], v[180:183]
    ds_read_b128 v[32:35], v6 offset:21504
    v_mfma_f32_16x16x32_bf16 v[184:187], v[76:79], v[140:143], v[184:187]
    ds_read_b128 v[36:39], v6 offset:22528
    v_mfma_f32_16x16x32_bf16 v[188:191], v[80:83], v[140:143], v[188:191]
    ds_read_b128 v[40:43], v6 offset:23552
    v_mfma_f32_16x16x32_bf16 v[192:195], v[84:87], v[140:143], v[192:195]
    ds_read_b128 v[44:47], v6 offset:24576
    s_add_u32 s78, s98, 8
    s_cmp_ge_u32 s78, 12
    s_cselect_b32 s18, 12, 0
    s_sub_u32 s78, s78, s18
    s_mul_i32 s78, s78, 4096
    s_add_u32 s78, s78, s67
    buffer_load_dwordx4 v[140:143], v172, s[8:11], s78 offen sc1
    s_waitcnt vmcnt(20)
    v_mfma_f32_16x16x32_bf16 v[196:199], v[68:71], v[144:147], v[196:199]
    v_mfma_f32_16x16x32_bf16 v[200:203], v[72:75], v[144:147], v[200:203]
    v_mfma_f32_16x16x32_bf16 v[204:207], v[76:79], v[144:147], v[204:207]
    v_mfma_f32_16x16x32_bf16 v[208:211], v[80:83], v[144:147], v[208:211]
    v_mfma_f32_16x16x32_bf16 v[212:215], v[84:87], v[144:147], v[212:215]
    buffer_load_dwordx4 v[144:147], v173, s[8:11], s78 offen sc1
    s_waitcnt vmcnt(20)
    v_mfma_f32_16x16x32_bf16 v[216:219], v[68:71], v[148:151], v[216:219]
    v_mfma_f32_16x16x32_bf16 v[220:223], v[72:75], v[148:151], v[220:223]
    v_mfma_f32_16x16x32_bf16 v[224:227], v[76:79], v[148:151], v[224:227]
    v_mfma_f32_16x16x32_bf16 v[228:231], v[80:83], v[148:151], v[228:231]
    v_mfma_f32_16x16x32_bf16 v[232:235], v[84:87], v[148:151], v[232:235]
    buffer_load_dwordx4 v[148:151], v174, s[8:11], s78 offen sc1
    s_waitcnt vmcnt(20)
    v_mfma_f32_16x16x32_bf16 v[236:239], v[68:71], v[152:155], v[236:239]
    v_mfma_f32_16x16x32_bf16 v[240:243], v[72:75], v[152:155], v[240:243]
    v_mfma_f32_16x16x32_bf16 v[244:247], v[76:79], v[152:155], v[244:247]
    v_mfma_f32_16x16x32_bf16 v[248:251], v[80:83], v[152:155], v[248:251]
    v_mfma_f32_16x16x32_bf16 v[252:255], v[84:87], v[152:155], v[252:255]
    buffer_load_dwordx4 v[152:155], v175, s[8:11], s78 offen sc1
    s_waitcnt lgkmcnt(0)
    s_waitcnt vmcnt(20)
    v_mfma_f32_16x16x32_bf16 v[176:179], v[28:31], v[156:159], v[176:179]
    v_mfma_f32_16x16x32_bf16 v[180:183], v[32:35], v[156:159], v[180:183]
    v_mfma_f32_16x16x32_bf16 v[184:187], v[36:39], v[156:159], v[184:187]
    v_mfma_f32_16x16x32_bf16 v[188:191], v[40:43], v[156:159], v[188:191]
    v_mfma_f32_16x16x32_bf16 v[192:195], v[44:47], v[156:159], v[192:195]
    s_add_u32 s78, s98, 11
    s_cmp_ge_u32 s78, 12
    s_cselect_b32 s18, 12, 0
    s_sub_u32 s78, s78, s18
    s_mul_i32 s78, s78, 4096
    s_add_u32 s78, s78, s67
    buffer_load_dwordx4 v[156:159], v172, s[8:11], s78 offen sc1
    s_waitcnt vmcnt(20)
    v_mfma_f32_16x16x32_bf16 v[196:199], v[28:31], v[160:163], v[196:199]
    v_mfma_f32_16x16x32_bf16 v[200:203], v[32:35], v[160:163], v[200:203]
    v_mfma_f32_16x16x32_bf16 v[204:207], v[36:39], v[160:163], v[204:207]
    v_mfma_f32_16x16x32_bf16 v[208:211], v[40:43], v[160:163], v[208:211]
    v_mfma_f32_16x16x32_bf16 v[212:215], v[44:47], v[160:163], v[212:215]
    buffer_load_dwordx4 v[160:163], v173, s[8:11], s78 offen sc1
    s_waitcnt vmcnt(20)
    v_mfma_f32_16x16x32_bf16 v[216:219], v[28:31], v[164:167], v[216:219]
    v_mfma_f32_16x16x32_bf16 v[220:223], v[32:35], v[164:167], v[220:223]
    v_mfma_f32_16x16x32_bf16 v[224:227], v[36:39], v[164:167], v[224:227]
    v_mfma_f32_16x16x32_bf16 v[228:231], v[40:43], v[164:167], v[228:231]
    v_mfma_f32_16x16x32_bf16 v[232:235], v[44:47], v[164:167], v[232:235]
    buffer_load_dwordx4 v[164:167], v174, s[8:11], s78 offen sc1
    s_waitcnt vmcnt(20)
    v_mfma_f32_16x16x32_bf16 v[236:239], v[28:31], v[168:171], v[236:239]
    v_mfma_f32_16x16x32_bf16 v[240:243], v[32:35], v[168:171], v[240:243]
    v_mfma_f32_16x16x32_bf16 v[244:247], v[36:39], v[168:171], v[244:247]
    v_mfma_f32_16x16x32_bf16 v[248:251], v[40:43], v[168:171], v[248:251]
    v_mfma_f32_16x16x32_bf16 v[252:255], v[44:47], v[168:171], v[252:255]
    buffer_load_dwordx4 v[168:171], v175, s[8:11], s78 offen sc1
    s_waitcnt lgkmcnt(0)
    s_cmp_ge_u32 s31, 6
    s_cbranch_scc1 Lwg_43
    s_mov_b32 s30, 0
Lp_44:
    ds_read_b32 v4, v3 offset:40
    s_waitcnt lgkmcnt(0)
    v_readfirstlane_b32 s31, v4
    s_cmp_ge_u32 s31, 6
    s_cbranch_scc1 Lpd_45
    s_add_u32 s30, s30, 1
    s_cmp_lt_u32 s30, 262144
    s_cbranch_scc1 Lp_44
Lpd_45:
Lwg_43:
    s_waitcnt vmcnt(12)
    v_mfma_f32_16x16x32_bf16 v[176:179], v[88:91], v[108:111], v[176:179]
    ds_read_b128 v[48:51], v6 offset:40992
    s_add_u32 s28, s3, 1
    s_and_b32 s28, s28, 3
    v_mfma_f32_16x16x32_bf16 v[180:183], v[92:95], v[108:111], v[180:183]
    ds_read_b128 v[52:55], v6 offset:42016
    s_mul_i32 s28, s28, 5120
    s_add_u32 s28, s28, 40992
    v_mfma_f32_16x16x32_bf16 v[184:187], v[96:99], v[108:111], v[184:187]
    ds_read_b128 v[56:59], v6 offset:43040
    v_add_u32 v28, s28, v0
    s_add_u32 s28, s3, 2
    v_mfma_f32_16x16x32_bf16 v[188:191], v[100:103], v[108:111], v[188:191]
    ds_read_b128 v[60:63], v6 offset:44064
    s_and_b32 s28, s28, 3
    s_mul_i32 s28, s28, 5120
    v_mfma_f32_16x16x32_bf16 v[192:195], v[104:107], v[108:111], v[192:195]
    ds_read_b128 v[64:67], v6 offset:45088
    s_add_u32 s28, s28, 20480
    v_add_u32 v29, s28, v0
    s_waitcnt vmcnt(19)
    v_mfma_f32_16x16x32_bf16 v[196:199], v[88:91], v[112:115], v[196:199]
    ds_read_b128 v[68:71], v5 offset:0
    s_add_u32 s28, s3, 3
    s_and_b32 s28, s28, 3
    v_mfma_f32_16x16x32_bf16 v[200:203], v[92:95], v[112:115], v[200:203]
    ds_read_b128 v[72:75], v5 offset:1024
    s_mul_i32 s28, s28, 5120
    s_add_u32 s28, s28, 0
    v_mfma_f32_16x16x32_bf16 v[204:207], v[96:99], v[112:115], v[204:207]
    ds_read_b128 v[76:79], v5 offset:2048
    v_add_u32 v30, s28, v0
    v_and_b32 v42, 15, v1
    v_mfma_f32_16x16x32_bf16 v[208:211], v[100:103], v[112:115], v[208:211]
    ds_read_b128 v[80:83], v5 offset:3072
    s_lshl_b32 s28, s3, 6
    s_add_u32 s28, s28, 143456
    v_mfma_f32_16x16x32_bf16 v[212:215], v[104:107], v[112:115], v[212:215]
    ds_read_b128 v[84:87], v5 offset:4096
    v_lshl_add_u32 v31, v42, 2, s28
    v_mul_u32_u24 v42, 160, v42
    s_waitcnt vmcnt(18)
    v_mfma_f32_16x16x32_bf16 v[216:219], v[88:91], v[116:119], v[216:219]
    s_mul_i32 s28, s3, 2560
    s_add_u32 s28, s28, 133216
    v_add_u32 v42, s28, v42
    v_lshrrev_b32 v43, 4, v1
    v_mfma_f32_16x16x32_bf16 v[220:223], v[92:95], v[116:119], v[220:223]
    v_lshl_add_u32 v33, v43, 3, v42
    v_lshl_add_u32 v32, v43, 4, v42
    v_add_u32 v34, s28, v0
    s_mov_b32 s28, 143968
    v_mfma_f32_16x16x32_bf16 v[224:227], v[96:99], v[116:119], v[224:227]
    v_lshl_add_u32 v40, v43, 4, s28
    v_lshl_add_u32 v41, v43, 3, s28
    v_bfe_u32 v44, v1, 2, 2
    v_and_b32 v45, 3, v1
    v_mfma_f32_16x16x32_bf16 v[228:231], v[100:103], v[116:119], v[228:231]
    v_lshl_add_u32 v35, v43, 3, v44
    v_lshlrev_b32 v35, 7, v35
    v_lshl_add_u32 v35, v45, 3, v35
    s_lshl_b32 s28, s3, 5
    v_mfma_f32_16x16x32_bf16 v[232:235], v[104:107], v[116:119], v[232:235]
    s_add_u32 s28, s28, 122976
    v_add_u32 v35, s28, v35
    v_lshl_add_u32 v36, v43, 2, v44
    v_lshlrev_b32 v36, 7, v36
    s_waitcnt vmcnt(17)
    v_mfma_f32_16x16x32_bf16 v[236:239], v[88:91], v[120:123], v[236:239]
    v_lshl_add_u32 v36, v45, 3, v36
    s_add_u32 s28, s28, 8192
    v_add_u32 v36, s28, v36
    v_and_b32 v42, 8, v1
    v_mfma_f32_16x16x32_bf16 v[240:243], v[92:95], v[120:123], v[240:243]
    v_and_b32 v44, 15, v1
    v_add_u32 v42, v42, v44
    v_mul_u32_u24 v42, 1280, v42
    v_lshl_add_u32 v37, v43, 4, v42
    v_mfma_f32_16x16x32_bf16 v[244:247], v[96:99], v[120:123], v[244:247]
    v_lshl_add_u32 v38, v43, 3, v42
    v_mfma_f32_16x16x32_bf16 v[248:251], v[100:103], v[120:123], v[248:251]
    v_mfma_f32_16x16x32_bf16 v[252:255], v[104:107], v[120:123], v[252:255]
    s_waitcnt lgkmcnt(0)
    s_waitcnt vmcnt(29)
    s_waitcnt vmcnt(11)
    v_mfma_f32_16x16x32_bf16 v[176:179], v[48:51], v[124:127], v[176:179]
    v_mfma_f32_16x16x32_bf16 v[180:183], v[52:55], v[124:127], v[180:183]
    v_mfma_f32_16x16x32_bf16 v[184:187], v[56:59], v[124:127], v[184:187]
    v_mfma_f32_16x16x32_bf16 v[188:191], v[60:63], v[124:127], v[188:191]
    v_mfma_f32_16x16x32_bf16 v[192:195], v[64:67], v[124:127], v[192:195]
    s_waitcnt vmcnt(7)
    v_mfma_f32_16x16x32_bf16 v[176:179], v[68:71], v[140:143], v[176:179]
    v_mfma_f32_16x16x32_bf16 v[180:183], v[72:75], v[140:143], v[180:183]
    v_mfma_f32_16x16x32_bf16 v[184:187], v[76:79], v[140:143], v[184:187]
    v_mfma_f32_16x16x32_bf16 v[188:191], v[80:83], v[140:143], v[188:191]
    v_mfma_f32_16x16x32_bf16 v[192:195], v[84:87], v[140:143], v[192:195]
    s_waitcnt vmcnt(3)
    v_mfma_f32_16x16x32_bf16 v[176:179], v[8:11], v[156:159], v[176:179]
    v_mfma_f32_16x16x32_bf16 v[180:183], v[12:15], v[156:159], v[180:183]
    v_mfma_f32_16x16x32_bf16 v[184:187], v[16:19], v[156:159], v[184:187]
    v_mfma_f32_16x16x32_bf16 v[188:191], v[20:23], v[156:159], v[188:191]
    v_mfma_f32_16x16x32_bf16 v[192:195], v[24:27], v[156:159], v[192:195]
    v_mfma_f32_16x16x32_bf16 v[196:199], v[48:51], v[128:131], v[196:199]
    ds_read_b32 v4, v3 offset:52
    v_mfma_f32_16x16x32_bf16 v[200:203], v[52:55], v[128:131], v[200:203]
    s_nop 0
    ds_write_b128 v6, v[176:179] offset:0
    v_mfma_f32_16x16x32_bf16 v[204:207], v[56:59], v[128:131], v[204:207]
    v_mfma_f32_16x16x32_bf16 v[208:211], v[60:63], v[128:131], v[208:211]
    ds_write_b128 v6, v[180:183] offset:1024
    v_mfma_f32_16x16x32_bf16 v[212:215], v[64:67], v[128:131], v[212:215]
    v_mfma_f32_16x16x32_bf16 v[196:199], v[68:71], v[144:147], v[196:199]
    s_waitcnt lgkmcnt(2)
    v_readfirstlane_b32 s31, v4
    s_cmp_ge_u32 s31, 1
    s_cbranch_scc1 Lpre_46
    s_mov_b32 s30, 0
Lp_47:
    ds_read_b32 v4, v3 offset:52
    s_waitcnt lgkmcnt(0)
    v_readfirstlane_b32 s31, v4
    s_cmp_ge_u32 s31, 1
    s_cbranch_scc1 Lpd_48
    s_add_u32 s30, s30, 1
    s_cmp_lt_u32 s30, 262144
    s_cbranch_scc1 Lp_47
Lpd_48:
Lpre_46:
    ds_read_b128 v[120:123], v32
    ds_read_b128 v[108:111], v40
    ds_read_b128 v[172:175], v32 offset:64
    ds_read_b128 v[112:115], v40 offset:64
    ds_read_b64 v[118:119], v33 offset:128
    ds_read_b64 v[116:117], v41 offset:128
    ds_read_b32 v46, v31
    ds_read_b32 v47, v31 offset:256
    ds_write_b128 v6, v[184:187] offset:2048
    v_mfma_f32_16x16x32_bf16 v[200:203], v[72:75], v[144:147], v[200:203]
    v_mfma_f32_16x16x32_bf16 v[204:207], v[76:79], v[144:147], v[204:207]
    ds_write_b128 v6, v[188:191] offset:3072
    v_mfma_f32_16x16x32_bf16 v[208:211], v[80:83], v[144:147], v[208:211]
    v_mfma_f32_16x16x32_bf16 v[212:215], v[84:87], v[144:147], v[212:215]
    ds_write_b128 v6, v[192:195] offset:4096
    s_waitcnt vmcnt(2)
    v_mfma_f32_16x16x32_bf16 v[196:199], v[8:11], v[160:163], v[196:199]
    v_mfma_f32_16x16x32_bf16 v[200:203], v[12:15], v[160:163], v[200:203]
    s_waitcnt lgkmcnt(3)
    v_and_b32 v42, 0xffff, v108
    v_and_b32 v43, 0xffff0000, v108
    v_mfma_f32_16x16x32_bf16 v[204:207], v[16:19], v[160:163], v[204:207]
    v_dot2_f32_bf16 v88, v120, v42, 0
    v_dot2_f32_bf16 v89, v120, v43, 0
    v_mfma_f32_16x16x32_bf16 v[208:211], v[20:23], v[160:163], v[208:211]
    v_and_b32 v42, 0xffff, v109
    v_and_b32 v43, 0xffff0000, v109
    v_mfma_f32_16x16x32_bf16 v[212:215], v[24:27], v[160:163], v[212:215]
    v_dot2_f32_bf16 v90, v121, v42, 0
    v_dot2_f32_bf16 v91, v121, v43, 0
    v_mfma_f32_16x16x32_bf16 v[216:219], v[48:51], v[132:135], v[216:219]
    v_and_b32 v42, 0xffff, v110
    v_and_b32 v43, 0xffff0000, v110
    v_mfma_f32_16x16x32_bf16 v[220:223], v[52:55], v[132:135], v[220:223]
    ds_write_b128 v6, v[196:199] offset:20480
    v_dot2_f32_bf16 v92, v122, v42, 0
    v_dot2_f32_bf16 v93, v122, v43, 0
    v_mfma_f32_16x16x32_bf16 v[224:227], v[56:59], v[132:135], v[224:227]
    v_and_b32 v42, 0xffff, v111
    v_and_b32 v43, 0xffff0000, v111
    v_mfma_f32_16x16x32_bf16 v[228:231], v[60:63], v[132:135], v[228:231]
    ds_write_b128 v6, v[200:203] offset:21504
    v_dot2_f32_bf16 v94, v123, v42, 0
    v_dot2_f32_bf16 v95, v123, v43, 0
    v_mfma_f32_16x16x32_bf16 v[232:235], v[64:67], v[132:135], v[232:235]
    v_and_b32 v42, 0xffff, v112
    v_and_b32 v43, 0xffff0000, v112
    v_mfma_f32_16x16x32_bf16 v[216:219], v[68:71], v[148:151], v[216:219]
    ds_write_b128 v6, v[204:207] offset:22528
    v_dot2_f32_bf16 v96, v172, v42, 0
    v_dot2_f32_bf16 v97, v172, v43, 0
    v_mfma_f32_16x16x32_bf16 v[220:223], v[72:75], v[148:151], v[220:223]
    v_and_b32 v42, 0xffff, v113
    v_and_b32 v43, 0xffff0000, v113
    v_mfma_f32_16x16x32_bf16 v[224:227], v[76:79], v[148:151], v[224:227]
    ds_write_b128 v6, v[208:211] offset:23552
    v_dot2_f32_bf16 v98, v173, v42, 0
    v_dot2_f32_bf16 v99, v173, v43, 0
    v_mfma_f32_16x16x32_bf16 v[228:231], v[80:83], v[148:151], v[228:231]
    v_and_b32 v42, 0xffff, v114
    v_and_b32 v43, 0xffff0000, v114
    v_mfma_f32_16x16x32_bf16 v[232:235], v[84:87], v[148:151], v[232:235]
    ds_write_b128 v6, v[212:215] offset:24576
    v_dot2_f32_bf16 v100, v174, v42, 0
    v_dot2_f32_bf16 v101, v174, v43, 0
    s_waitcnt vmcnt(1)
    v_mfma_f32_16x16x32_bf16 v[216:219], v[8:11], v[164:167], v[216:219]
    v_and_b32 v42, 0xffff, v115
    v_and_b32 v43, 0xffff0000, v115
    v_mfma_f32_16x16x32_bf16 v[220:223], v[12:15], v[164:167], v[220:223]
    v_dot2_f32_bf16 v102, v175, v42, 0
    v_dot2_f32_bf16 v103, v175, v43, 0
    v_mfma_f32_16x16x32_bf16 v[224:227], v[16:19], v[164:167], v[224:227]
    v_and_b32 v42, 0xffff, v116
    v_and_b32 v43, 0xffff0000, v116
    v_mfma_f32_16x16x32_bf16 v[228:231], v[20:23], v[164:167], v[228:231]
    v_dot2_f32_bf16 v104, v118, v42, 0
    v_dot2_f32_bf16 v105, v118, v43, 0
    v_mfma_f32_16x16x32_bf16 v[232:235], v[24:27], v[164:167], v[232:235]
    v_and_b32 v42, 0xffff, v117
    v_and_b32 v43, 0xffff0000, v117
    v_mfma_f32_16x16x32_bf16 v[236:239], v[48:51], v[136:139], v[236:239]
    v_dot2_f32_bf16 v106, v119, v42, 0
    v_dot2_f32_bf16 v107, v119, v43, 0
    v_mfma_f32_16x16x32_bf16 v[240:243], v[52:55], v[136:139], v[240:243]
    ds_write_b128 v6, v[216:219] offset:40992
    v_mfma_f32_16x16x32_bf16 v[244:247], v[56:59], v[136:139], v[244:247]
    v_mfma_f32_16x16x32_bf16 v[248:251], v[60:63], v[136:139], v[248:251]
    ds_write_b128 v6, v[220:223] offset:42016
    v_mfma_f32_16x16x32_bf16 v[252:255], v[64:67], v[136:139], v[252:255]
    v_mfma_f32_16x16x32_bf16 v[236:239], v[68:71], v[152:155], v[236:239]
    ds_write_b128 v6, v[224:227] offset:43040
    v_mfma_f32_16x16x32_bf16 v[240:243], v[72:75], v[152:155], v[240:243]
    v_mfma_f32_16x16x32_bf16 v[244:247], v[76:79], v[152:155], v[244:247]
    ds_write_b128 v6, v[228:231] offset:44064
    v_mfma_f32_16x16x32_bf16 v[248:251], v[80:83], v[152:155], v[248:251]
    v_mfma_f32_16x16x32_bf16 v[252:255], v[84:87], v[152:155], v[252:255]
    ds_write_b128 v6, v[232:235] offset:45088
    s_waitcnt vmcnt(0)
    v_mfma_f32_16x16x32_bf16 v[236:239], v[8:11], v[168:171], v[236:239]
    v_mfma_f32_16x16x32_bf16 v[240:243], v[12:15], v[168:171], v[240:243]
    v_mfma_f32_16x16x32_bf16 v[244:247], v[16:19], v[168:171], v[244:247]
    s_waitcnt lgkmcnt(0)
    s_mov_b64 exec, 1
    ds_add_u32 v3, v2 offset:44
    s_mov_b64 exec, -1
    v_mfma_f32_16x16x32_bf16 v[248:251], v[20:23], v[168:171], v[248:251]
    v_mfma_f32_16x16x32_bf16 v[252:255], v[24:27], v[168:171], v[252:255]
    ds_read_b32 v4, v3 offset:44
    s_waitcnt lgkmcnt(0)
    v_readfirstlane_b32 s31, v4
    s_cmp_ge_u32 s31, 4
    s_cbranch_scc1 Lrd_49
    s_mov_b32 s30, 0
Lp_50:
    ds_read_b32 v4, v3 offset:44
    s_waitcnt lgkmcnt(0)
    v_readfirstlane_b32 s31, v4
    s_cmp_ge_u32 s31, 4
    s_cbranch_scc1 Lpd_51
    s_add_u32 s30, s30, 1
    s_cmp_lt_u32 s30, 262144
    s_cbranch_scc1 Lp_50
Lpd_51:
Lrd_49:
    ds_read_b128 v[176:179], v28 offset:0
    ds_read_b128 v[180:183], v28 offset:1024
    ds_read_b128 v[184:187], v28 offset:2048
    ds_read_b128 v[188:191], v28 offset:3072
    ds_read_b128 v[192:195], v28 offset:4096
    ds_read_b128 v[196:199], v29 offset:0
    ds_read_b128 v[200:203], v29 offset:1024
    ds_read_b128 v[204:207], v29 offset:2048
    ds_read_b128 v[208:211], v29 offset:3072
    ds_read_b128 v[212:215], v29 offset:4096
    ds_read_b128 v[216:219], v30 offset:0
    ds_read_b128 v[220:223], v30 offset:1024
    ds_read_b128 v[224:227], v30 offset:2048
    ds_read_b128 v[228:231], v30 offset:3072
    ds_read_b128 v[232:235], v30 offset:4096
    ds_read_b32 v4, v3 offset:56
    s_waitcnt lgkmcnt(15)
    v_pk_add_f32 v[236:237], v[236:237], v[176:177]
    v_pk_add_f32 v[238:239], v[238:239], v[178:179]
    s_waitcnt lgkmcnt(14)
    v_pk_add_f32 v[240:241], v[240:241], v[180:181]
    v_pk_add_f32 v[242:243], v[242:243], v[182:183]
    s_waitcnt lgkmcnt(13)
    v_pk_add_f32 v[244:245], v[244:245], v[184:185]
    v_pk_add_f32 v[246:247], v[246:247], v[186:187]
    s_waitcnt lgkmcnt(12)
    v_pk_add_f32 v[248:249], v[248:249], v[188:189]
    v_pk_add_f32 v[250:251], v[250:251], v[190:191]
    s_waitcnt lgkmcnt(11)
    v_pk_add_f32 v[252:253], v[252:253], v[192:193]
    v_pk_add_f32 v[254:255], v[254:255], v[194:195]
    s_waitcnt lgkmcnt(10)
    v_pk_add_f32 v[236:237], v[236:237], v[196:197]
    v_pk_add_f32 v[238:239], v[238:239], v[198:199]
    s_waitcnt lgkmcnt(9)
    v_pk_add_f32 v[240:241], v[240:241], v[200:201]
    v_pk_add_f32 v[242:243], v[242:243], v[202:203]
    s_waitcnt lgkmcnt(8)
    v_pk_add_f32 v[244:245], v[244:245], v[204:205]
    v_pk_add_f32 v[246:247], v[246:247], v[206:207]
    s_waitcnt lgkmcnt(7)
    v_pk_add_f32 v[248:249], v[248:249], v[208:209]
    v_pk_add_f32 v[250:251], v[250:251], v[210:211]
    s_waitcnt lgkmcnt(6)
    v_pk_add_f32 v[252:253], v[252:253], v[212:213]
    v_pk_add_f32 v[254:255], v[254:255], v[214:215]
    s_waitcnt lgkmcnt(5)
    v_pk_add_f32 v[236:237], v[236:237], v[216:217]
    v_pk_add_f32 v[238:239], v[238:239], v[218:219]
    s_waitcnt lgkmcnt(4)
    v_pk_add_f32 v[240:241], v[240:241], v[220:221]
    v_pk_add_f32 v[242:243], v[242:243], v[222:223]
    s_waitcnt lgkmcnt(3)
    v_pk_add_f32 v[244:245], v[244:245], v[224:225]
    v_pk_add_f32 v[246:247], v[246:247], v[226:227]
    s_waitcnt lgkmcnt(2)
    v_pk_add_f32 v[248:249], v[248:249], v[228:229]
    v_pk_add_f32 v[250:251], v[250:251], v[230:231]
    s_waitcnt lgkmcnt(1)
    v_pk_add_f32 v[252:253], v[252:253], v[232:233]
    v_pk_add_f32 v[254:255], v[254:255], v[234:235]
    s_waitcnt lgkmcnt(0)
    v_readfirstlane_b32 s31, v4
    s_cmp_ge_u32 s31, 1
    s_cbranch_scc1 Ly_52
    s_mov_b32 s30, 0
Lp_53:
    ds_read_b32 v4, v3 offset:56
    s_waitcnt lgkmcnt(0)
    v_readfirstlane_b32 s31, v4
    s_cmp_ge_u32 s31, 1
    s_cbranch_scc1 Lpd_54
    s_add_u32 s30, s30, 1
    s_cmp_lt_u32 s30, 262144
    s_cbranch_scc1 Lp_53
Lpd_54:
Ly_52:
    ds_read_b64_tr_b16 v[8:9], v35 offset:0
    ds_read_b64_tr_b16 v[10:11], v35 offset:512
    ds_read_b64_tr_b16 v[12:13], v35 offset:4096
    ds_read_b64_tr_b16 v[14:15], v35 offset:4608
    ds_read_b64_tr_b16 v[16:17], v36
    v_pk_mul_f32 v[236:237], v[236:237], v[46:47] op_sel:[0,1] op_sel_hi:[1,1]
    v_pk_mul_f32 v[238:239], v[238:239], v[46:47] op_sel:[0,1] op_sel_hi:[1,1]
    v_pk_mul_f32 v[240:241], v[240:241], v[46:47] op_sel:[0,1] op_sel_hi:[1,1]
    v_pk_mul_f32 v[242:243], v[242:243], v[46:47] op_sel:[0,1] op_sel_hi:[1,1]
    v_pk_mul_f32 v[244:245], v[244:245], v[46:47] op_sel:[0,1] op_sel_hi:[1,1]
    v_pk_mul_f32 v[246:247], v[246:247], v[46:47] op_sel:[0,1] op_sel_hi:[1,1]
    v_pk_mul_f32 v[248:249], v[248:249], v[46:47] op_sel:[0,1] op_sel_hi:[1,1]
    v_pk_mul_f32 v[250:251], v[250:251], v[46:47] op_sel:[0,1] op_sel_hi:[1,1]
    v_pk_mul_f32 v[252:253], v[252:253], v[46:47] op_sel:[0,1] op_sel_hi:[1,1]
    v_pk_mul_f32 v[254:255], v[254:255], v[46:47] op_sel:[0,1] op_sel_hi:[1,1]
    s_waitcnt lgkmcnt(4)
    v_dot2c_f32_bf16 v88, s40, v8
    v_dot2c_f32_bf16 v89, s41, v8
    v_dot2c_f32_bf16 v90, s40, v9
    v_dot2c_f32_bf16 v91, s41, v9
    s_waitcnt lgkmcnt(3)
    v_dot2c_f32_bf16 v92, s40, v10
    v_dot2c_f32_bf16 v93, s41, v10
    v_dot2c_f32_bf16 v94, s40, v11
    v_dot2c_f32_bf16 v95, s41, v11
    s_waitcnt lgkmcnt(2)
    v_dot2c_f32_bf16 v96, s40, v12
    v_dot2c_f32_bf16 v97, s41, v12
    v_dot2c_f32_bf16 v98, s40, v13
    v_dot2c_f32_bf16 v99, s41, v13
    s_waitcnt lgkmcnt(1)
    v_dot2c_f32_bf16 v100, s40, v14
    v_dot2c_f32_bf16 v101, s41, v14
    v_dot2c_f32_bf16 v102, s40, v15
    v_dot2c_f32_bf16 v103, s41, v15
    s_waitcnt lgkmcnt(0)
    v_dot2c_f32_bf16 v104, s40, v16
    v_dot2c_f32_bf16 v105, s41, v16
    v_dot2c_f32_bf16 v106, s40, v17
    v_dot2c_f32_bf16 v107, s41, v17
    v_pk_fma_f32 v[88:89], v[88:89], v[46:47], v[236:237] op_sel:[0,0,0] op_sel_hi:[1,0,1]
    v_pk_fma_f32 v[90:91], v[90:91], v[46:47], v[238:239] op_sel:[0,0,0] op_sel_hi:[1,0,1]
    v_pk_fma_f32 v[92:93], v[92:93], v[46:47], v[240:241] op_sel:[0,0,0] op_sel_hi:[1,0,1]
    v_pk_fma_f32 v[94:95], v[94:95], v[46:47], v[242:243] op_sel:[0,0,0] op_sel_hi:[1,0,1]
    v_cvt_pk_bf16_f32 v48, v88, v89
    v_cvt_pk_bf16_f32 v49, v90, v91
    v_cvt_pk_bf16_f32 v50, v92, v93
    v_cvt_pk_bf16_f32 v51, v94, v95
    buffer_store_dwordx4 v[48:51], v37, s[68:71], s72 offen offset:0
    v_pk_fma_f32 v[96:97], v[96:97], v[46:47], v[244:245] op_sel:[0,0,0] op_sel_hi:[1,0,1]
    v_pk_fma_f32 v[98:99], v[98:99], v[46:47], v[246:247] op_sel:[0,0,0] op_sel_hi:[1,0,1]
    v_pk_fma_f32 v[100:101], v[100:101], v[46:47], v[248:249] op_sel:[0,0,0] op_sel_hi:[1,0,1]
    v_pk_fma_f32 v[102:103], v[102:103], v[46:47], v[250:251] op_sel:[0,0,0] op_sel_hi:[1,0,1]
    v_cvt_pk_bf16_f32 v52, v96, v97
    v_cvt_pk_bf16_f32 v53, v98, v99
    v_cvt_pk_bf16_f32 v54, v100, v101
    v_cvt_pk_bf16_f32 v55, v102, v103
    buffer_store_dwordx4 v[52:55], v37, s[68:71], s72 offen offset:64
    v_pk_fma_f32 v[104:105], v[104:105], v[46:47], v[252:253] op_sel:[0,0,0] op_sel_hi:[1,0,1]
    v_pk_fma_f32 v[106:107], v[106:107], v[46:47], v[254:255] op_sel:[0,0,0] op_sel_hi:[1,0,1]
    v_cvt_pk_bf16_f32 v56, v104, v105
    v_cvt_pk_bf16_f32 v57, v106, v107
    buffer_store_dwordx2 v[56:57], v38, s[68:71], s72 offen offset:128
    s_endpgm
Lslow_25:
    s_mov_b32 s51, 0
Lslow_25x:
    ds_read_b32 v113, v3 offset:32
    s_waitcnt lgkmcnt(0)
    v_readfirstlane_b32 s50, v113
    s_cmp_gt_u32 s50, 9
    s_cbranch_scc1 Lback_26
    s_sleep 1
    s_add_u32 s51, s51, 1
    s_cmp_lt_u32 s51, 262144
    s_cbranch_scc1 Lslow_25x
    s_branch Lback_26
.p2align 7
Lnot_gemm:
    s_load_dwordx8 s[56:63], s[0:1], 8
    s_load_dwordx2 s[64:65], s[0:1], 40
    s_load_dwordx2 s[72:73], s[0:1], 88
    s_lshr_b32 s30, s29, 1
    s_lshl_b32 s30, s30, 3
    s_add_u32 s30, s30, s28
    s_sub_u32 s54, s3, 4
    s_mul_i32 s53, s30, 5
    s_and_b32 s30, s29, 1
    s_mul_i32 s30, s30, 3
    s_add_u32 s30, s30, s54
    s_add_u32 s53, s53, s30
    s_cmp_eq_u32 s30, 5
    s_cbranch_scc1 Lwd
    s_mul_i32 s42, s53, 384
    s_lshl_b32 s43, s53, 1
    v_lshl_add_u32 v2, v1, 1, s42
    v_mov_b32 v3, s43
    v_mov_b64 v[8:9], 0
    v_mov_b64 v[10:11], 0
    v_mov_b64 v[12:13], 0
    v_mov_b64 v[14:15], 0
    v_mov_b64 v[16:17], 0
    v_mov_b64 v[18:19], 0
    v_mov_b64 v[20:21], 0
    s_waitcnt lgkmcnt(0)
    global_load_short_d16_hi v20, v3, s[64:65]
    global_load_short_d16_hi v10, v2, s[60:61] offset:0 nt
    global_load_short_d16_hi v14, v2, s[60:61] offset:128 nt
    global_load_short_d16_hi v18, v2, s[60:61] offset:256 nt
    global_load_short_d16_hi v11, v2, s[62:63] offset:0 nt
    global_load_short_d16_hi v15, v2, s[62:63] offset:128 nt
    global_load_short_d16_hi v19, v2, s[62:63] offset:256 nt
    global_load_short_d16_hi v8, v2, s[56:57] offset:0 nt
    global_load_short_d16_hi v12, v2, s[56:57] offset:128 nt
    global_load_short_d16_hi v16, v2, s[56:57] offset:256 nt
    global_load_short_d16_hi v9, v2, s[58:59] offset:0 nt
    global_load_short_d16_hi v13, v2, s[58:59] offset:128 nt
    global_load_short_d16_hi v17, v2, s[58:59] offset:256 nt
    s_lshr_b32 s30, s28, 2
    s_lshl_b32 s30, s30, 3
    s_lshr_b32 s31, s29, 2
    s_add_u32 s101, s30, s31
    s_and_b32 s30, s28, 3
    s_and_b32 s31, s29, 3
    s_lshl_b32 s14, s30, 2
    s_add_u32 s14, s14, s31
    s_mul_i32 s31, s31, 5
    s_add_u32 s31, s31, 1
    s_lshr_b32 s31, s31, 1
    s_lshr_b32 s30, s29, 2
    s_add_u32 s31, s31, s30
    s_lshr_b32 s30, s29, 4
    s_add_u32 s17, s31, s30
    s_cmp_ge_u32 s17, 10
    s_cselect_b32 s30, 10, 0
    s_sub_u32 s17, s17, s30
    s_and_b32 s28, s2, 7
    s_lshr_b32 s29, s2, 3
    s_lshr_b32 s30, s29, 3
    s_lshl_b32 s15, s28, 2
    s_add_u32 s15, s15, s30
    s_and_b32 s16, s29, 7
    s_mul_i32 s30, s30, 3
    s_mul_i32 s31, s16, 3
    s_lshr_b32 s31, s31, 1
    s_add_u32 s98, s30, s31
    s_cmp_ge_u32 s98, 12
    s_cselect_b32 s30, 12, 0
    s_sub_u32 s98, s98, s30
    s_lshr_b32 s29, s29, 1
    s_lshl_b32 s29, s29, 3
    s_add_u32 s99, s29, s28
    s_lshr_b32 s28, s15, 1
    s_lshl_b32 s28, s28, 7
    s_and_b32 s29, s15, 1
    s_lshl_b32 s29, s29, 3
    s_add_u32 s100, s28, s29
    s_mul_i32 s52, s54, 13568
    s_add_u32 s52, s52, 122976
    s_setprio 0
    s_setreg_imm32_b32 hwreg(HW_REG_MODE, 9, 1), 0
    v_mov_b64 v[24:25], 0
    v_mov_b64 v[26:27], 0
    v_lshlrev_b32 v4, 2, v1
    v_add_u32 v4, s52, v4
    v_lshlrev_b32 v6, 4, v1
    v_add_u32 v5, s52, v6
    v_mov_b32 v7, 163680
    s_mov_b64 exec, 0xffff
    ds_write_b32 v4, v24 offset:8256
    s_mov_b64 exec, 0x3fffffff
    ds_write_b128 v5, v[24:27] offset:8320
    s_mov_b64 exec, -1
    s_cmp_lg_u32 s54, 0
    s_cbranch_scc1 Lcnz
    v_add_u32 v5, v7, v6
    s_mov_b64 exec, 0x1f
    ds_write_b128 v5, v[24:27]
    s_mov_b64 exec, -1
Lcnz:
    s_waitcnt lgkmcnt(0)
    s_mov_b32 s8, s22
    s_mov_b32 s9, s23
    s_mov_b32 s10, 33554432
    s_mov_b32 s11, 0x00020000
    s_add_u32 s28, s22, 14680064
    s_addc_u32 s29, s23, 0
    s_load_dword s12, s[28:29], 0
    s_mov_b32 s74, 1280
    s_mov_b32 s75, 0x00020000
    v_mul_u32_u24 v2, 112, v1
    v_add_u32 v2, s52, v2
    v_lshrrev_b32 v3, 5, v1
    v_mul_u32_u24 v3, 224, v3
    v_bfe_u32 v4, v1, 2, 2
    v_mul_u32_u24 v4, 448, v4
    v_add_u32 v3, v3, v4
    v_bfe_u32 v4, v1, 4, 1
    v_lshl_add_u32 v3, v4, 5, v3
    v_and_b32 v4, 3, v1
    v_lshl_add_u32 v3, v4, 3, v3
    v_add_u32 v3, s52, v3
    s_add_u32 s28, s52, 1008
    v_sub_u32 v5, s28, v6
    s_mov_b32 s44, 0x3fb8aa3b
    s_mov_b32 s45, 0x3e22f983
    s_mov_b32 s47, 0x43800000
    s_lshr_b32 s28, s53, 4
    s_lshl_b32 s28, s28, 6
    s_add_u32 s76, s28, 14688256
    s_lshl_b32 s77, s53, 12
    s_add_u32 s78, s77, 11534336
    s_add_u32 s77, s77, 8388608
    v_mov_b32 v127, 0
    v_mov_b32 v139, 0
    v_mov_b32 v183, 0
    v_mov_b32 v195, 0
    v_mov_b32 v239, 0
    v_mov_b32 v251, 0
    s_nop 0
    s_waitcnt lgkmcnt(0)
    s_mul_i32 s12, s12, 0x9E3779B1
    s_add_u32 s12, s12, 0x7F4A7C15
    s_mov_b32 s13, s12
    s_waitcnt vmcnt(6)
    v_mul_f32 v20, s44, v20
    v_max3_f32 v22, |v10|, |v14|, |v18|
    v_exp_f32 v20, v20
    v_max3_f32 v23, |v11|, |v15|, |v19|
    v_max_f32 v22, v22, v23
    v_cvt_pk_bf16_f32 v20, v20, v20
    s_nop 0
    v_max_f32_dpp v22, v22, v22 row_shr:1 row_mask:0xf bank_mask:0xf
    s_nop 1
    v_max_f32_dpp v22, v22, v22 row_shr:2 row_mask:0xf bank_mask:0xf
    s_nop 1
    v_max_f32_dpp v22, v22, v22 row_shr:4 row_mask:0xf bank_mask:0xf
    s_nop 1
    v_max_f32_dpp v22, v22, v22 row_shr:8 row_mask:0xf bank_mask:0xf
    v_and_b32 v20, 0xffff0000, v20
    s_nop 0
    v_max_f32_dpp v22, v22, v22 row_bcast:15 row_mask:0xa bank_mask:0xf
    v_mul_f32 v21, s45, v20
    s_nop 0
    v_max_f32_dpp v22, v22, v22 row_bcast:31 row_mask:0xc bank_mask:0xf
    v_add_f32 v23, v20, v20
    v_readlane_b32 s48, v22, 63
    v_mul_f32 v20, s44, v20
    s_lshr_b32 s48, s48, 23
    s_sub_u32 s48, 265, s48
    s_min_u32 s48, s48, 253
    s_sub_u32 s49, 254, s48
    s_lshl_b32 s48, s48, 23
    s_lshl_b32 s49, s49, 23
    v_mul_f32 v22, s49, v23
    s_waitcnt vmcnt(0)
    v_mul_f32 v8, s44, v8
    v_mul_f32 v9, v21, v9
    v_exp_f32 v8, v8
    v_mul_f32 v41, s47, v9
    v_fract_f32 v9, v9
    v_cvt_pk_bf16_f32 v8, v8, v8
    v_fract_f32 v41, v41
    v_and_b32 v8, 0xffff0000, v8
    v_cos_f32 v24, v9
    v_mul_f32 v8, v20, v8
    v_sin_f32 v25, v9
    v_mul_f32 v40, s47, v8
    v_exp_f32 v8, -v8
    v_cos_f32 v34, v41
    v_sin_f32 v35, v41
    v_exp_f32 v40, -v40
    v_mul_f32 v24, v24, v8
    v_mul_f32 v25, v25, v8
    v_mul_f32 v34, v34, v40
    v_mul_f32 v35, v35, v40
    v_mul_f32 v52, s48, v10
    v_mul_f32 v53, s48, -v11
    v_mul_f32 v40, v25, v25
    v_mul_f32 v41, v35, v35
    v_mul_f32 v27, v24, v25 mul:2
    v_mul_f32 v37, v34, v35 mul:2
    v_fma_f32 v26, v24, v24, -v40
    v_fma_f32 v36, v34, v34, -v41
    v_cvt_pk_f16_f32 v42, v24, v25
    v_cvt_pk_f16_f32 v44, v34, v35
    v_mul_f32 v40, v27, v27
    v_mul_f32 v41, v37, v37
    v_mul_f32 v29, v26, v27 mul:2
    v_mul_f32 v39, v36, v37 mul:2
    v_fma_f32 v28, v26, v26, -v40
    v_fma_f32 v38, v36, v36, -v41
    v_cvt_pk_f16_f32 v43, v26, v27
    v_cvt_pk_f16_f32 v45, v36, v37
    v_mul_f32 v40, v29, v29
    v_mul_f32 v54, v52, v28
    v_mul_f32 v31, v28, v29 mul:2
    v_mul_f32 v55, v53, v28
    v_fma_f32 v30, v28, v28, -v40
    v_fma_f32 v54, v53, v29, v54
    v_fma_f32 v55, -v52, v29, v55
    v_cvt_pk_f16_f32 v46, v38, v39
    v_mul_f32 v40, v31, v31
    v_cvt_pk_f16_f32 v120, v52, v54
    v_mul_f32 v33, v30, v31 mul:2
    v_cvt_pk_f16_f32 v132, v53, v55
    v_fma_f32 v32, v30, v30, -v40
    v_cvt_pk_f16_f32 v88, 1.0, v30
    v_cvt_pk_f16_f32 v104, 0, v31
    v_mul_f32 v40, v33, v33
    v_pk_mul_f16 v121, v132, v43 op_sel:[0,1] op_sel_hi:[1,1]
    v_mul_f32 v31, v32, v33 mul:2
    v_pk_mul_f16 v133, v132, v43 op_sel:[0,0] op_sel_hi:[1,0]
    v_fma_f32 v30, v32, v32, -v40
    v_pk_fma_f16 v121, v120, v43, v121 op_sel:[0,0,0] op_sel_hi:[1,0,1]
    v_cvt_pk_f16_f32 v47, v32, v33
    v_pk_fma_f16 v133, v120, v43, v133 op_sel:[0,1,0] op_sel_hi:[1,1,1] neg_lo:[1,0,0] neg_hi:[1,0,0]
    v_mul_f32 v40, v31, v31
    v_pk_mul_f16 v128, v132, v45 op_sel:[0,1] op_sel_hi:[1,1]
    v_pk_mul_f16 v89, v104, v47 op_sel:[0,1] op_sel_hi:[1,1]
    v_mul_f32 v33, v30, v31 mul:2
    v_pk_mul_f16 v140, v132, v45 op_sel:[0,0] op_sel_hi:[1,0]
    v_pk_mul_f16 v105, v104, v47 op_sel:[0,0] op_sel_hi:[1,0]
    v_fma_f32 v32, v30, v30, -v40
    v_pk_fma_f16 v128, v120, v45, v128 op_sel:[0,0,0] op_sel_hi:[1,0,1]
    v_pk_fma_f16 v89, v88, v47, v89 op_sel:[0,0,0] op_sel_hi:[1,0,1] neg_lo:[0,0,1] neg_hi:[0,0,1]
    v_cvt_pk_f16_f32 v48, v30, v31
    v_pk_fma_f16 v140, v120, v45, v140 op_sel:[0,1,0] op_sel_hi:[1,1,1] neg_lo:[1,0,0] neg_hi:[1,0,0]
    v_pk_fma_f16 v105, v88, v47, v105 op_sel:[0,1,0] op_sel_hi:[1,1,1]
    v_mul_f32 v40, v33, v33
    v_pk_mul_f16 v122, v132, v44 op_sel:[0,1] op_sel_hi:[1,1]
    v_pk_mul_f16 v90, v104, v48 op_sel:[0,1] op_sel_hi:[1,1]
    v_mul_f32 v31, v32, v33 mul:2
    v_pk_mul_f16 v134, v132, v44 op_sel:[0,0] op_sel_hi:[1,0]
    v_pk_mul_f16 v106, v104, v48 op_sel:[0,0] op_sel_hi:[1,0]
    v_fma_f32 v30, v32, v32, -v40
    v_pk_fma_f16 v122, v120, v44, v122 op_sel:[0,0,0] op_sel_hi:[1,0,1]
    v_pk_fma_f16 v90, v88, v48, v90 op_sel:[0,0,0] op_sel_hi:[1,0,1] neg_lo:[0,0,1] neg_hi:[0,0,1]
    v_cvt_pk_f16_f32 v49, v32, v33
    v_pk_fma_f16 v134, v120, v44, v134 op_sel:[0,1,0] op_sel_hi:[1,1,1] neg_lo:[1,0,0] neg_hi:[1,0,0]
    v_pk_fma_f16 v106, v88, v48, v106 op_sel:[0,1,0] op_sel_hi:[1,1,1]
    v_cvt_pk_f16_f32 v50, v30, v31
    v_pk_mul_f16 v124, v132, v42 op_sel:[0,1] op_sel_hi:[1,1]
    v_pk_mul_f16 v91, v105, v48 op_sel:[0,1] op_sel_hi:[1,1]
    v_pack_b32_f16 v56, v120, v128
    v_pk_mul_f16 v136, v132, v42 op_sel:[0,0] op_sel_hi:[1,0]
    v_pk_mul_f16 v107, v105, v48 op_sel:[0,0] op_sel_hi:[1,0]
    v_pack_b32_f16 v57, v132, v140
    v_pk_fma_f16 v124, v120, v42, v124 op_sel:[0,0,0] op_sel_hi:[1,0,1]
    v_pk_fma_f16 v91, v89, v48, v91 op_sel:[0,0,0] op_sel_hi:[1,0,1] neg_lo:[0,0,1] neg_hi:[0,0,1]
    v_pk_fma_f16 v136, v120, v42, v136 op_sel:[0,1,0] op_sel_hi:[1,1,1] neg_lo:[1,0,0] neg_hi:[1,0,0]
    v_pk_fma_f16 v107, v89, v48, v107 op_sel:[0,1,0] op_sel_hi:[1,1,1]
    v_pk_mul_f16 v125, v133, v42 op_sel:[0,1] op_sel_hi:[1,1]
    v_pk_mul_f16 v92, v104, v49 op_sel:[0,1] op_sel_hi:[1,1]
    v_pk_mul_f16 v93, v105, v49 op_sel:[0,1] op_sel_hi:[1,1]
    v_pk_mul_f16 v137, v133, v42 op_sel:[0,0] op_sel_hi:[1,0]
    v_pk_mul_f16 v108, v104, v49 op_sel:[0,0] op_sel_hi:[1,0]
    v_pk_mul_f16 v109, v105, v49 op_sel:[0,0] op_sel_hi:[1,0]
    v_pk_fma_f16 v125, v121, v42, v125 op_sel:[0,0,0] op_sel_hi:[1,0,1]
    v_pk_fma_f16 v92, v88, v49, v92 op_sel:[0,0,0] op_sel_hi:[1,0,1] neg_lo:[0,0,1] neg_hi:[0,0,1]
    v_pk_fma_f16 v93, v89, v49, v93 op_sel:[0,0,0] op_sel_hi:[1,0,1] neg_lo:[0,0,1] neg_hi:[0,0,1]
    v_pk_fma_f16 v137, v121, v42, v137 op_sel:[0,1,0] op_sel_hi:[1,1,1] neg_lo:[1,0,0] neg_hi:[1,0,0]
    v_pk_fma_f16 v108, v88, v49, v108 op_sel:[0,1,0] op_sel_hi:[1,1,1]
    v_pk_fma_f16 v109, v89, v49, v109 op_sel:[0,1,0] op_sel_hi:[1,1,1]
    v_pk_mul_f16 v129, v57, v46 op_sel:[0,1] op_sel_hi:[1,1]
    v_pk_mul_f16 v94, v106, v49 op_sel:[0,1] op_sel_hi:[1,1]
    v_pk_mul_f16 v95, v107, v49 op_sel:[0,1] op_sel_hi:[1,1]
    v_pk_mul_f16 v141, v57, v46 op_sel:[0,0] op_sel_hi:[1,0]
    v_pk_mul_f16 v110, v106, v49 op_sel:[0,0] op_sel_hi:[1,0]
    v_pk_mul_f16 v111, v107, v49 op_sel:[0,0] op_sel_hi:[1,0]
    v_pk_fma_f16 v129, v56, v46, v129 op_sel:[0,0,0] op_sel_hi:[1,0,1]
    v_pk_fma_f16 v94, v90, v49, v94 op_sel:[0,0,0] op_sel_hi:[1,0,1] neg_lo:[0,0,1] neg_hi:[0,0,1]
    v_pk_fma_f16 v95, v91, v49, v95 op_sel:[0,0,0] op_sel_hi:[1,0,1] neg_lo:[0,0,1] neg_hi:[0,0,1]
    v_pk_fma_f16 v141, v56, v46, v141 op_sel:[0,1,0] op_sel_hi:[1,1,1] neg_lo:[1,0,0] neg_hi:[1,0,0]
    v_pk_fma_f16 v110, v90, v49, v110 op_sel:[0,1,0] op_sel_hi:[1,1,1]
    v_pk_fma_f16 v111, v91, v49, v111 op_sel:[0,1,0] op_sel_hi:[1,1,1]
    v_pk_mul_f16 v123, v133, v44 op_sel:[0,1] op_sel_hi:[1,1]
    v_pk_mul_f16 v96, v104, v50 op_sel:[0,1] op_sel_hi:[1,1]
    v_pk_mul_f16 v97, v105, v50 op_sel:[0,1] op_sel_hi:[1,1]
    v_pk_mul_f16 v135, v133, v44 op_sel:[0,0] op_sel_hi:[1,0]
    v_pk_mul_f16 v112, v104, v50 op_sel:[0,0] op_sel_hi:[1,0]
    v_pk_mul_f16 v113, v105, v50 op_sel:[0,0] op_sel_hi:[1,0]
    v_pk_fma_f16 v123, v121, v44, v123 op_sel:[0,0,0] op_sel_hi:[1,0,1]
    v_pk_fma_f16 v96, v88, v50, v96 op_sel:[0,0,0] op_sel_hi:[1,0,1] neg_lo:[0,0,1] neg_hi:[0,0,1]
    v_pk_fma_f16 v97, v89, v50, v97 op_sel:[0,0,0] op_sel_hi:[1,0,1] neg_lo:[0,0,1] neg_hi:[0,0,1]
    v_pk_fma_f16 v135, v121, v44, v135 op_sel:[0,1,0] op_sel_hi:[1,1,1] neg_lo:[1,0,0] neg_hi:[1,0,0]
    v_pk_fma_f16 v112, v88, v50, v112 op_sel:[0,1,0] op_sel_hi:[1,1,1]
    v_pk_fma_f16 v113, v89, v50, v113 op_sel:[0,1,0] op_sel_hi:[1,1,1]
    v_pk_mul_f16 v130, v134, v45 op_sel:[0,1] op_sel_hi:[1,1]
    v_pk_mul_f16 v98, v106, v50 op_sel:[0,1] op_sel_hi:[1,1]
    v_pk_mul_f16 v99, v107, v50 op_sel:[0,1] op_sel_hi:[1,1]
    v_pk_mul_f16 v142, v134, v45 op_sel:[0,0] op_sel_hi:[1,0]
    v_pk_mul_f16 v114, v106, v50 op_sel:[0,0] op_sel_hi:[1,0]
    v_pk_mul_f16 v115, v107, v50 op_sel:[0,0] op_sel_hi:[1,0]
    v_pk_fma_f16 v130, v122, v45, v130 op_sel:[0,0,0] op_sel_hi:[1,0,1]
    v_pk_fma_f16 v98, v90, v50, v98 op_sel:[0,0,0] op_sel_hi:[1,0,1] neg_lo:[0,0,1] neg_hi:[0,0,1]
    v_pk_fma_f16 v99, v91, v50, v99 op_sel:[0,0,0] op_sel_hi:[1,0,1] neg_lo:[0,0,1] neg_hi:[0,0,1]
    v_pk_fma_f16 v142, v122, v45, v142 op_sel:[0,1,0] op_sel_hi:[1,1,1] neg_lo:[1,0,0] neg_hi:[1,0,0]
    v_pk_fma_f16 v114, v90, v50, v114 op_sel:[0,1,0] op_sel_hi:[1,1,1]
    v_pk_fma_f16 v115, v91, v50, v115 op_sel:[0,1,0] op_sel_hi:[1,1,1]
    v_pk_mul_f16 v131, v141, v44 op_sel:[0,1] op_sel_hi:[1,1]
    v_pk_mul_f16 v100, v108, v50 op_sel:[0,1] op_sel_hi:[1,1]
    v_pk_mul_f16 v101, v109, v50 op_sel:[0,1] op_sel_hi:[1,1]
    v_pk_mul_f16 v143, v141, v44 op_sel:[0,0] op_sel_hi:[1,0]
    v_pk_mul_f16 v116, v108, v50 op_sel:[0,0] op_sel_hi:[1,0]
    v_pk_mul_f16 v117, v109, v50 op_sel:[0,0] op_sel_hi:[1,0]
    v_pk_fma_f16 v131, v129, v44, v131 op_sel:[0,0,0] op_sel_hi:[1,0,1]
    v_pk_fma_f16 v100, v92, v50, v100 op_sel:[0,0,0] op_sel_hi:[1,0,1] neg_lo:[0,0,1] neg_hi:[0,0,1]
    v_pk_fma_f16 v101, v93, v50, v101 op_sel:[0,0,0] op_sel_hi:[1,0,1] neg_lo:[0,0,1] neg_hi:[0,0,1]
    v_pk_fma_f16 v143, v129, v44, v143 op_sel:[0,1,0] op_sel_hi:[1,1,1] neg_lo:[1,0,0] neg_hi:[1,0,0]
    v_pk_fma_f16 v116, v92, v50, v116 op_sel:[0,1,0] op_sel_hi:[1,1,1]
    v_pk_fma_f16 v117, v93, v50, v117 op_sel:[0,1,0] op_sel_hi:[1,1,1]
    v_pk_mul_f16 v126, v141, v46 op_sel:[0,1] op_sel_hi:[1,1]
    v_pk_mul_f16 v102, v110, v50 op_sel:[0,1] op_sel_hi:[1,1]
    v_pk_mul_f16 v103, v111, v50 op_sel:[0,1] op_sel_hi:[1,1]
    v_pk_mul_f16 v138, v141, v46 op_sel:[0,0] op_sel_hi:[1,0]
    v_pk_mul_f16 v118, v110, v50 op_sel:[0,0] op_sel_hi:[1,0]
    v_pk_mul_f16 v119, v111, v50 op_sel:[0,0] op_sel_hi:[1,0]
    v_pk_fma_f16 v126, v129, v46, v126 op_sel:[0,0,0] op_sel_hi:[1,0,1]
    v_pk_fma_f16 v102, v94, v50, v102 op_sel:[0,0,0] op_sel_hi:[1,0,1] neg_lo:[0,0,1] neg_hi:[0,0,1]
    v_pk_fma_f16 v103, v95, v50, v103 op_sel:[0,0,0] op_sel_hi:[1,0,1] neg_lo:[0,0,1] neg_hi:[0,0,1]
    v_pk_fma_f16 v138, v129, v46, v138 op_sel:[0,1,0] op_sel_hi:[1,1,1] neg_lo:[1,0,0] neg_hi:[1,0,0]
    v_pk_fma_f16 v118, v94, v50, v118 op_sel:[0,1,0] op_sel_hi:[1,1,1]
    v_pk_fma_f16 v119, v95, v50, v119 op_sel:[0,1,0] op_sel_hi:[1,1,1]
    v_mul_f32 v12, s44, v12
    v_mul_f32 v13, v21, v13
    v_exp_f32 v12, v12
    v_mul_f32 v41, s47, v13
    v_fract_f32 v13, v13
    v_cvt_pk_bf16_f32 v12, v12, v12
    v_fract_f32 v41, v41
    v_and_b32 v12, 0xffff0000, v12
    v_cos_f32 v24, v13
    v_mul_f32 v12, v20, v12
    v_sin_f32 v25, v13
    v_mul_f32 v40, s47, v12
    v_exp_f32 v12, -v12
    v_cos_f32 v34, v41
    v_sin_f32 v35, v41
    v_exp_f32 v40, -v40
    v_mul_f32 v24, v24, v12
    v_mul_f32 v25, v25, v12
    v_mul_f32 v34, v34, v40
    v_mul_f32 v35, v35, v40
    v_mul_f32 v52, s48, v14
    v_mul_f32 v53, s48, -v15
    v_mul_f32 v40, v25, v25
    v_mul_f32 v41, v35, v35
    v_mul_f32 v27, v24, v25 mul:2
    v_mul_f32 v37, v34, v35 mul:2
    v_fma_f32 v26, v24, v24, -v40
    v_fma_f32 v36, v34, v34, -v41
    v_cvt_pk_f16_f32 v42, v24, v25
    v_cvt_pk_f16_f32 v44, v34, v35
    v_mul_f32 v40, v27, v27
    v_mul_f32 v41, v37, v37
    v_mul_f32 v29, v26, v27 mul:2
    v_mul_f32 v39, v36, v37 mul:2
    v_fma_f32 v28, v26, v26, -v40
    v_fma_f32 v38, v36, v36, -v41
    v_cvt_pk_f16_f32 v43, v26, v27
    v_cvt_pk_f16_f32 v45, v36, v37
    v_mul_f32 v40, v29, v29
    v_mul_f32 v54, v52, v28
    v_mul_f32 v31, v28, v29 mul:2
    v_mul_f32 v55, v53, v28
    v_fma_f32 v30, v28, v28, -v40
    v_fma_f32 v54, v53, v29, v54
    v_fma_f32 v55, -v52, v29, v55
    v_cvt_pk_f16_f32 v46, v38, v39
    v_mul_f32 v40, v31, v31
    v_cvt_pk_f16_f32 v176, v52, v54
    v_mul_f32 v33, v30, v31 mul:2
    v_cvt_pk_f16_f32 v188, v53, v55
    v_fma_f32 v32, v30, v30, -v40
    v_cvt_pk_f16_f32 v144, 1.0, v30
    v_cvt_pk_f16_f32 v160, 0, v31
    v_mul_f32 v40, v33, v33
    v_pk_mul_f16 v177, v188, v43 op_sel:[0,1] op_sel_hi:[1,1]
    v_mul_f32 v31, v32, v33 mul:2
    v_pk_mul_f16 v189, v188, v43 op_sel:[0,0] op_sel_hi:[1,0]
    v_fma_f32 v30, v32, v32, -v40
    v_pk_fma_f16 v177, v176, v43, v177 op_sel:[0,0,0] op_sel_hi:[1,0,1]
    v_cvt_pk_f16_f32 v47, v32, v33
    v_pk_fma_f16 v189, v176, v43, v189 op_sel:[0,1,0] op_sel_hi:[1,1,1] neg_lo:[1,0,0] neg_hi:[1,0,0]
    v_mul_f32 v40, v31, v31
    v_pk_mul_f16 v184, v188, v45 op_sel:[0,1] op_sel_hi:[1,1]
    v_pk_mul_f16 v145, v160, v47 op_sel:[0,1] op_sel_hi:[1,1]
    v_mul_f32 v33, v30, v31 mul:2
    v_pk_mul_f16 v196, v188, v45 op_sel:[0,0] op_sel_hi:[1,0]
    v_pk_mul_f16 v161, v160, v47 op_sel:[0,0] op_sel_hi:[1,0]
    v_fma_f32 v32, v30, v30, -v40
    v_pk_fma_f16 v184, v176, v45, v184 op_sel:[0,0,0] op_sel_hi:[1,0,1]
    v_pk_fma_f16 v145, v144, v47, v145 op_sel:[0,0,0] op_sel_hi:[1,0,1] neg_lo:[0,0,1] neg_hi:[0,0,1]
    v_cvt_pk_f16_f32 v48, v30, v31
    v_pk_fma_f16 v196, v176, v45, v196 op_sel:[0,1,0] op_sel_hi:[1,1,1] neg_lo:[1,0,0] neg_hi:[1,0,0]
    v_pk_fma_f16 v161, v144, v47, v161 op_sel:[0,1,0] op_sel_hi:[1,1,1]
    v_mul_f32 v40, v33, v33
    v_pk_mul_f16 v178, v188, v44 op_sel:[0,1] op_sel_hi:[1,1]
    v_pk_mul_f16 v146, v160, v48 op_sel:[0,1] op_sel_hi:[1,1]
    v_mul_f32 v31, v32, v33 mul:2
    v_pk_mul_f16 v190, v188, v44 op_sel:[0,0] op_sel_hi:[1,0]
    v_pk_mul_f16 v162, v160, v48 op_sel:[0,0] op_sel_hi:[1,0]
    v_fma_f32 v30, v32, v32, -v40
    v_pk_fma_f16 v178, v176, v44, v178 op_sel:[0,0,0] op_sel_hi:[1,0,1]
    v_pk_fma_f16 v146, v144, v48, v146 op_sel:[0,0,0] op_sel_hi:[1,0,1] neg_lo:[0,0,1] neg_hi:[0,0,1]
    v_cvt_pk_f16_f32 v49, v32, v33
    v_pk_fma_f16 v190, v176, v44, v190 op_sel:[0,1,0] op_sel_hi:[1,1,1] neg_lo:[1,0,0] neg_hi:[1,0,0]
    v_pk_fma_f16 v162, v144, v48, v162 op_sel:[0,1,0] op_sel_hi:[1,1,1]
    v_cvt_pk_f16_f32 v50, v30, v31
    v_pk_mul_f16 v180, v188, v42 op_sel:[0,1] op_sel_hi:[1,1]
    v_pk_mul_f16 v147, v161, v48 op_sel:[0,1] op_sel_hi:[1,1]
    v_pack_b32_f16 v56, v176, v184
    v_pk_mul_f16 v192, v188, v42 op_sel:[0,0] op_sel_hi:[1,0]
    v_pk_mul_f16 v163, v161, v48 op_sel:[0,0] op_sel_hi:[1,0]
    v_pack_b32_f16 v57, v188, v196
    v_pk_fma_f16 v180, v176, v42, v180 op_sel:[0,0,0] op_sel_hi:[1,0,1]
    v_pk_fma_f16 v147, v145, v48, v147 op_sel:[0,0,0] op_sel_hi:[1,0,1] neg_lo:[0,0,1] neg_hi:[0,0,1]
    v_pk_fma_f16 v192, v176, v42, v192 op_sel:[0,1,0] op_sel_hi:[1,1,1] neg_lo:[1,0,0] neg_hi:[1,0,0]
    v_pk_fma_f16 v163, v145, v48, v163 op_sel:[0,1,0] op_sel_hi:[1,1,1]
    v_pk_mul_f16 v181, v189, v42 op_sel:[0,1] op_sel_hi:[1,1]
    v_pk_mul_f16 v148, v160, v49 op_sel:[0,1] op_sel_hi:[1,1]
    v_pk_mul_f16 v149, v161, v49 op_sel:[0,1] op_sel_hi:[1,1]
    v_pk_mul_f16 v193, v189, v42 op_sel:[0,0] op_sel_hi:[1,0]
    v_pk_mul_f16 v164, v160, v49 op_sel:[0,0] op_sel_hi:[1,0]
    v_pk_mul_f16 v165, v161, v49 op_sel:[0,0] op_sel_hi:[1,0]
    v_pk_fma_f16 v181, v177, v42, v181 op_sel:[0,0,0] op_sel_hi:[1,0,1]
    v_pk_fma_f16 v148, v144, v49, v148 op_sel:[0,0,0] op_sel_hi:[1,0,1] neg_lo:[0,0,1] neg_hi:[0,0,1]
    v_pk_fma_f16 v149, v145, v49, v149 op_sel:[0,0,0] op_sel_hi:[1,0,1] neg_lo:[0,0,1] neg_hi:[0,0,1]
    v_pk_fma_f16 v193, v177, v42, v193 op_sel:[0,1,0] op_sel_hi:[1,1,1] neg_lo:[1,0,0] neg_hi:[1,0,0]
    v_pk_fma_f16 v164, v144, v49, v164 op_sel:[0,1,0] op_sel_hi:[1,1,1]
    v_pk_fma_f16 v165, v145, v49, v165 op_sel:[0,1,0] op_sel_hi:[1,1,1]
    v_pk_mul_f16 v185, v57, v46 op_sel:[0,1] op_sel_hi:[1,1]
    v_pk_mul_f16 v150, v162, v49 op_sel:[0,1] op_sel_hi:[1,1]
    v_pk_mul_f16 v151, v163, v49 op_sel:[0,1] op_sel_hi:[1,1]
    v_pk_mul_f16 v197, v57, v46 op_sel:[0,0] op_sel_hi:[1,0]
    v_pk_mul_f16 v166, v162, v49 op_sel:[0,0] op_sel_hi:[1,0]
    v_pk_mul_f16 v167, v163, v49 op_sel:[0,0] op_sel_hi:[1,0]
    v_pk_fma_f16 v185, v56, v46, v185 op_sel:[0,0,0] op_sel_hi:[1,0,1]
    v_pk_fma_f16 v150, v146, v49, v150 op_sel:[0,0,0] op_sel_hi:[1,0,1] neg_lo:[0,0,1] neg_hi:[0,0,1]
    v_pk_fma_f16 v151, v147, v49, v151 op_sel:[0,0,0] op_sel_hi:[1,0,1] neg_lo:[0,0,1] neg_hi:[0,0,1]
    v_pk_fma_f16 v197, v56, v46, v197 op_sel:[0,1,0] op_sel_hi:[1,1,1] neg_lo:[1,0,0] neg_hi:[1,0,0]
    v_pk_fma_f16 v166, v146, v49, v166 op_sel:[0,1,0] op_sel_hi:[1,1,1]
    v_pk_fma_f16 v167, v147, v49, v167 op_sel:[0,1,0] op_sel_hi:[1,1,1]
    v_pk_mul_f16 v179, v189, v44 op_sel:[0,1] op_sel_hi:[1,1]
    v_pk_mul_f16 v152, v160, v50 op_sel:[0,1] op_sel_hi:[1,1]
    v_pk_mul_f16 v153, v161, v50 op_sel:[0,1] op_sel_hi:[1,1]
    v_pk_mul_f16 v191, v189, v44 op_sel:[0,0] op_sel_hi:[1,0]
    v_pk_mul_f16 v168, v160, v50 op_sel:[0,0] op_sel_hi:[1,0]
    v_pk_mul_f16 v169, v161, v50 op_sel:[0,0] op_sel_hi:[1,0]
    v_pk_fma_f16 v179, v177, v44, v179 op_sel:[0,0,0] op_sel_hi:[1,0,1]
    v_pk_fma_f16 v152, v144, v50, v152 op_sel:[0,0,0] op_sel_hi:[1,0,1] neg_lo:[0,0,1] neg_hi:[0,0,1]
    v_pk_fma_f16 v153, v145, v50, v153 op_sel:[0,0,0] op_sel_hi:[1,0,1] neg_lo:[0,0,1] neg_hi:[0,0,1]
    v_pk_fma_f16 v191, v177, v44, v191 op_sel:[0,1,0] op_sel_hi:[1,1,1] neg_lo:[1,0,0] neg_hi:[1,0,0]
    v_pk_fma_f16 v168, v144, v50, v168 op_sel:[0,1,0] op_sel_hi:[1,1,1]
    v_pk_fma_f16 v169, v145, v50, v169 op_sel:[0,1,0] op_sel_hi:[1,1,1]
    v_pk_mul_f16 v186, v190, v45 op_sel:[0,1] op_sel_hi:[1,1]
    v_pk_mul_f16 v154, v162, v50 op_sel:[0,1] op_sel_hi:[1,1]
    v_pk_mul_f16 v155, v163, v50 op_sel:[0,1] op_sel_hi:[1,1]
    v_pk_mul_f16 v198, v190, v45 op_sel:[0,0] op_sel_hi:[1,0]
    v_pk_mul_f16 v170, v162, v50 op_sel:[0,0] op_sel_hi:[1,0]
    v_pk_mul_f16 v171, v163, v50 op_sel:[0,0] op_sel_hi:[1,0]
    v_pk_fma_f16 v186, v178, v45, v186 op_sel:[0,0,0] op_sel_hi:[1,0,1]
    v_pk_fma_f16 v154, v146, v50, v154 op_sel:[0,0,0] op_sel_hi:[1,0,1] neg_lo:[0,0,1] neg_hi:[0,0,1]
    v_pk_fma_f16 v155, v147, v50, v155 op_sel:[0,0,0] op_sel_hi:[1,0,1] neg_lo:[0,0,1] neg_hi:[0,0,1]
    v_pk_fma_f16 v198, v178, v45, v198 op_sel:[0,1,0] op_sel_hi:[1,1,1] neg_lo:[1,0,0] neg_hi:[1,0,0]
    v_pk_fma_f16 v170, v146, v50, v170 op_sel:[0,1,0] op_sel_hi:[1,1,1]
    v_pk_fma_f16 v171, v147, v50, v171 op_sel:[0,1,0] op_sel_hi:[1,1,1]
    v_pk_mul_f16 v187, v197, v44 op_sel:[0,1] op_sel_hi:[1,1]
    v_pk_mul_f16 v156, v164, v50 op_sel:[0,1] op_sel_hi:[1,1]
    v_pk_mul_f16 v157, v165, v50 op_sel:[0,1] op_sel_hi:[1,1]
    v_pk_mul_f16 v199, v197, v44 op_sel:[0,0] op_sel_hi:[1,0]
    v_pk_mul_f16 v172, v164, v50 op_sel:[0,0] op_sel_hi:[1,0]
    v_pk_mul_f16 v173, v165, v50 op_sel:[0,0] op_sel_hi:[1,0]
    v_pk_fma_f16 v187, v185, v44, v187 op_sel:[0,0,0] op_sel_hi:[1,0,1]
    v_pk_fma_f16 v156, v148, v50, v156 op_sel:[0,0,0] op_sel_hi:[1,0,1] neg_lo:[0,0,1] neg_hi:[0,0,1]
    v_pk_fma_f16 v157, v149, v50, v157 op_sel:[0,0,0] op_sel_hi:[1,0,1] neg_lo:[0,0,1] neg_hi:[0,0,1]
    v_pk_fma_f16 v199, v185, v44, v199 op_sel:[0,1,0] op_sel_hi:[1,1,1] neg_lo:[1,0,0] neg_hi:[1,0,0]
    v_pk_fma_f16 v172, v148, v50, v172 op_sel:[0,1,0] op_sel_hi:[1,1,1]
    v_pk_fma_f16 v173, v149, v50, v173 op_sel:[0,1,0] op_sel_hi:[1,1,1]
    v_pk_mul_f16 v182, v197, v46 op_sel:[0,1] op_sel_hi:[1,1]
    v_pk_mul_f16 v158, v166, v50 op_sel:[0,1] op_sel_hi:[1,1]
    v_pk_mul_f16 v159, v167, v50 op_sel:[0,1] op_sel_hi:[1,1]
    v_pk_mul_f16 v194, v197, v46 op_sel:[0,0] op_sel_hi:[1,0]
    v_pk_mul_f16 v174, v166, v50 op_sel:[0,0] op_sel_hi:[1,0]
    v_pk_mul_f16 v175, v167, v50 op_sel:[0,0] op_sel_hi:[1,0]
    v_pk_fma_f16 v182, v185, v46, v182 op_sel:[0,0,0] op_sel_hi:[1,0,1]
    v_pk_fma_f16 v158, v150, v50, v158 op_sel:[0,0,0] op_sel_hi:[1,0,1] neg_lo:[0,0,1] neg_hi:[0,0,1]
    v_pk_fma_f16 v159, v151, v50, v159 op_sel:[0,0,0] op_sel_hi:[1,0,1] neg_lo:[0,0,1] neg_hi:[0,0,1]
    v_pk_fma_f16 v194, v185, v46, v194 op_sel:[0,1,0] op_sel_hi:[1,1,1] neg_lo:[1,0,0] neg_hi:[1,0,0]
    v_pk_fma_f16 v174, v150, v50, v174 op_sel:[0,1,0] op_sel_hi:[1,1,1]
    v_pk_fma_f16 v175, v151, v50, v175 op_sel:[0,1,0] op_sel_hi:[1,1,1]
    v_mul_f32 v16, s44, v16
    v_mul_f32 v17, v21, v17
    v_exp_f32 v16, v16
    v_mul_f32 v41, s47, v17
    v_fract_f32 v17, v17
    v_cvt_pk_bf16_f32 v16, v16, v16
    v_fract_f32 v41, v41
    v_and_b32 v16, 0xffff0000, v16
    v_cos_f32 v24, v17
    v_mul_f32 v16, v20, v16
    v_sin_f32 v25, v17
    v_mul_f32 v40, s47, v16
    v_exp_f32 v16, -v16
    v_cos_f32 v34, v41
    v_sin_f32 v35, v41
    v_exp_f32 v40, -v40
    v_mul_f32 v24, v24, v16
    v_mul_f32 v25, v25, v16
    v_mul_f32 v34, v34, v40
    v_mul_f32 v35, v35, v40
    v_mul_f32 v52, s48, v18
    v_mul_f32 v53, s48, -v19
    v_mul_f32 v40, v25, v25
    v_mul_f32 v41, v35, v35
    v_mul_f32 v27, v24, v25 mul:2
    v_mul_f32 v37, v34, v35 mul:2
    v_fma_f32 v26, v24, v24, -v40
    v_fma_f32 v36, v34, v34, -v41
    v_cvt_pk_f16_f32 v42, v24, v25
    v_cvt_pk_f16_f32 v44, v34, v35
    v_mul_f32 v40, v27, v27
    v_mul_f32 v41, v37, v37
    v_mul_f32 v29, v26, v27 mul:2
    v_mul_f32 v39, v36, v37 mul:2
    v_fma_f32 v28, v26, v26, -v40
    v_fma_f32 v38, v36, v36, -v41
    v_cvt_pk_f16_f32 v43, v26, v27
    v_cvt_pk_f16_f32 v45, v36, v37
    v_mul_f32 v40, v29, v29
    v_mul_f32 v54, v52, v28
    v_mul_f32 v31, v28, v29 mul:2
    v_mul_f32 v55, v53, v28
    v_fma_f32 v30, v28, v28, -v40
    v_fma_f32 v54, v53, v29, v54
    v_fma_f32 v55, -v52, v29, v55
    v_cvt_pk_f16_f32 v46, v38, v39
    v_mul_f32 v40, v31, v31
    v_cvt_pk_f16_f32 v232, v52, v54
    v_mul_f32 v33, v30, v31 mul:2
    v_cvt_pk_f16_f32 v244, v53, v55
    v_fma_f32 v32, v30, v30, -v40
    v_cvt_pk_f16_f32 v200, 1.0, v30
    v_cvt_pk_f16_f32 v216, 0, v31
    v_mul_f32 v40, v33, v33
    v_pk_mul_f16 v233, v244, v43 op_sel:[0,1] op_sel_hi:[1,1]
    v_mul_f32 v31, v32, v33 mul:2
    v_pk_mul_f16 v245, v244, v43 op_sel:[0,0] op_sel_hi:[1,0]
    v_fma_f32 v30, v32, v32, -v40
    v_pk_fma_f16 v233, v232, v43, v233 op_sel:[0,0,0] op_sel_hi:[1,0,1]
    v_cvt_pk_f16_f32 v47, v32, v33
    v_pk_fma_f16 v245, v232, v43, v245 op_sel:[0,1,0] op_sel_hi:[1,1,1] neg_lo:[1,0,0] neg_hi:[1,0,0]
    v_mul_f32 v40, v31, v31
    v_pk_mul_f16 v240, v244, v45 op_sel:[0,1] op_sel_hi:[1,1]
    v_pk_mul_f16 v201, v216, v47 op_sel:[0,1] op_sel_hi:[1,1]
    v_mul_f32 v33, v30, v31 mul:2
    v_pk_mul_f16 v252, v244, v45 op_sel:[0,0] op_sel_hi:[1,0]
    v_pk_mul_f16 v217, v216, v47 op_sel:[0,0] op_sel_hi:[1,0]
    v_fma_f32 v32, v30, v30, -v40
    v_pk_fma_f16 v240, v232, v45, v240 op_sel:[0,0,0] op_sel_hi:[1,0,1]
    v_pk_fma_f16 v201, v200, v47, v201 op_sel:[0,0,0] op_sel_hi:[1,0,1] neg_lo:[0,0,1] neg_hi:[0,0,1]
    v_cvt_pk_f16_f32 v48, v30, v31
    v_pk_fma_f16 v252, v232, v45, v252 op_sel:[0,1,0] op_sel_hi:[1,1,1] neg_lo:[1,0,0] neg_hi:[1,0,0]
    v_pk_fma_f16 v217, v200, v47, v217 op_sel:[0,1,0] op_sel_hi:[1,1,1]
    v_mul_f32 v40, v33, v33
    v_pk_mul_f16 v234, v244, v44 op_sel:[0,1] op_sel_hi:[1,1]
    v_pk_mul_f16 v202, v216, v48 op_sel:[0,1] op_sel_hi:[1,1]
    v_mul_f32 v31, v32, v33 mul:2
    v_pk_mul_f16 v246, v244, v44 op_sel:[0,0] op_sel_hi:[1,0]
    v_pk_mul_f16 v218, v216, v48 op_sel:[0,0] op_sel_hi:[1,0]
    v_fma_f32 v30, v32, v32, -v40
    v_pk_fma_f16 v234, v232, v44, v234 op_sel:[0,0,0] op_sel_hi:[1,0,1]
    v_pk_fma_f16 v202, v200, v48, v202 op_sel:[0,0,0] op_sel_hi:[1,0,1] neg_lo:[0,0,1] neg_hi:[0,0,1]
    v_cvt_pk_f16_f32 v49, v32, v33
    v_pk_fma_f16 v246, v232, v44, v246 op_sel:[0,1,0] op_sel_hi:[1,1,1] neg_lo:[1,0,0] neg_hi:[1,0,0]
    v_pk_fma_f16 v218, v200, v48, v218 op_sel:[0,1,0] op_sel_hi:[1,1,1]
    v_cvt_pk_f16_f32 v50, v30, v31
    v_pk_mul_f16 v236, v244, v42 op_sel:[0,1] op_sel_hi:[1,1]
    v_pk_mul_f16 v203, v217, v48 op_sel:[0,1] op_sel_hi:[1,1]
    v_pack_b32_f16 v56, v232, v240
    v_pk_mul_f16 v248, v244, v42 op_sel:[0,0] op_sel_hi:[1,0]
    v_pk_mul_f16 v219, v217, v48 op_sel:[0,0] op_sel_hi:[1,0]
    v_pack_b32_f16 v57, v244, v252
    v_pk_fma_f16 v236, v232, v42, v236 op_sel:[0,0,0] op_sel_hi:[1,0,1]
    v_pk_fma_f16 v203, v201, v48, v203 op_sel:[0,0,0] op_sel_hi:[1,0,1] neg_lo:[0,0,1] neg_hi:[0,0,1]
    v_pk_fma_f16 v248, v232, v42, v248 op_sel:[0,1,0] op_sel_hi:[1,1,1] neg_lo:[1,0,0] neg_hi:[1,0,0]
    v_pk_fma_f16 v219, v201, v48, v219 op_sel:[0,1,0] op_sel_hi:[1,1,1]
    v_pk_mul_f16 v237, v245, v42 op_sel:[0,1] op_sel_hi:[1,1]
    v_pk_mul_f16 v204, v216, v49 op_sel:[0,1] op_sel_hi:[1,1]
    v_pk_mul_f16 v205, v217, v49 op_sel:[0,1] op_sel_hi:[1,1]
    v_pk_mul_f16 v249, v245, v42 op_sel:[0,0] op_sel_hi:[1,0]
    v_pk_mul_f16 v220, v216, v49 op_sel:[0,0] op_sel_hi:[1,0]
    v_pk_mul_f16 v221, v217, v49 op_sel:[0,0] op_sel_hi:[1,0]
    v_pk_fma_f16 v237, v233, v42, v237 op_sel:[0,0,0] op_sel_hi:[1,0,1]
    v_pk_fma_f16 v204, v200, v49, v204 op_sel:[0,0,0] op_sel_hi:[1,0,1] neg_lo:[0,0,1] neg_hi:[0,0,1]
    v_pk_fma_f16 v205, v201, v49, v205 op_sel:[0,0,0] op_sel_hi:[1,0,1] neg_lo:[0,0,1] neg_hi:[0,0,1]
    v_pk_fma_f16 v249, v233, v42, v249 op_sel:[0,1,0] op_sel_hi:[1,1,1] neg_lo:[1,0,0] neg_hi:[1,0,0]
    v_pk_fma_f16 v220, v200, v49, v220 op_sel:[0,1,0] op_sel_hi:[1,1,1]
    v_pk_fma_f16 v221, v201, v49, v221 op_sel:[0,1,0] op_sel_hi:[1,1,1]
    v_pk_mul_f16 v241, v57, v46 op_sel:[0,1] op_sel_hi:[1,1]
    v_pk_mul_f16 v206, v218, v49 op_sel:[0,1] op_sel_hi:[1,1]
    v_pk_mul_f16 v207, v219, v49 op_sel:[0,1] op_sel_hi:[1,1]
    v_pk_mul_f16 v253, v57, v46 op_sel:[0,0] op_sel_hi:[1,0]
    v_pk_mul_f16 v222, v218, v49 op_sel:[0,0] op_sel_hi:[1,0]
    v_pk_mul_f16 v223, v219, v49 op_sel:[0,0] op_sel_hi:[1,0]
    v_pk_fma_f16 v241, v56, v46, v241 op_sel:[0,0,0] op_sel_hi:[1,0,1]
    v_pk_fma_f16 v206, v202, v49, v206 op_sel:[0,0,0] op_sel_hi:[1,0,1] neg_lo:[0,0,1] neg_hi:[0,0,1]
    v_pk_fma_f16 v207, v203, v49, v207 op_sel:[0,0,0] op_sel_hi:[1,0,1] neg_lo:[0,0,1] neg_hi:[0,0,1]
    v_pk_fma_f16 v253, v56, v46, v253 op_sel:[0,1,0] op_sel_hi:[1,1,1] neg_lo:[1,0,0] neg_hi:[1,0,0]
    v_pk_fma_f16 v222, v202, v49, v222 op_sel:[0,1,0] op_sel_hi:[1,1,1]
    v_pk_fma_f16 v223, v203, v49, v223 op_sel:[0,1,0] op_sel_hi:[1,1,1]
    v_pk_mul_f16 v235, v245, v44 op_sel:[0,1] op_sel_hi:[1,1]
    v_pk_mul_f16 v208, v216, v50 op_sel:[0,1] op_sel_hi:[1,1]
    v_pk_mul_f16 v209, v217, v50 op_sel:[0,1] op_sel_hi:[1,1]
    v_pk_mul_f16 v247, v245, v44 op_sel:[0,0] op_sel_hi:[1,0]
    v_pk_mul_f16 v224, v216, v50 op_sel:[0,0] op_sel_hi:[1,0]
    v_pk_mul_f16 v225, v217, v50 op_sel:[0,0] op_sel_hi:[1,0]
    v_pk_fma_f16 v235, v233, v44, v235 op_sel:[0,0,0] op_sel_hi:[1,0,1]
    v_pk_fma_f16 v208, v200, v50, v208 op_sel:[0,0,0] op_sel_hi:[1,0,1] neg_lo:[0,0,1] neg_hi:[0,0,1]
    v_pk_fma_f16 v209, v201, v50, v209 op_sel:[0,0,0] op_sel_hi:[1,0,1] neg_lo:[0,0,1] neg_hi:[0,0,1]
    v_pk_fma_f16 v247, v233, v44, v247 op_sel:[0,1,0] op_sel_hi:[1,1,1] neg_lo:[1,0,0] neg_hi:[1,0,0]
    v_pk_fma_f16 v224, v200, v50, v224 op_sel:[0,1,0] op_sel_hi:[1,1,1]
    v_pk_fma_f16 v225, v201, v50, v225 op_sel:[0,1,0] op_sel_hi:[1,1,1]
    v_pk_mul_f16 v242, v246, v45 op_sel:[0,1] op_sel_hi:[1,1]
    v_pk_mul_f16 v210, v218, v50 op_sel:[0,1] op_sel_hi:[1,1]
    v_pk_mul_f16 v211, v219, v50 op_sel:[0,1] op_sel_hi:[1,1]
    v_pk_mul_f16 v254, v246, v45 op_sel:[0,0] op_sel_hi:[1,0]
    v_pk_mul_f16 v226, v218, v50 op_sel:[0,0] op_sel_hi:[1,0]
    v_pk_mul_f16 v227, v219, v50 op_sel:[0,0] op_sel_hi:[1,0]
    v_pk_fma_f16 v242, v234, v45, v242 op_sel:[0,0,0] op_sel_hi:[1,0,1]
    v_pk_fma_f16 v210, v202, v50, v210 op_sel:[0,0,0] op_sel_hi:[1,0,1] neg_lo:[0,0,1] neg_hi:[0,0,1]
    v_pk_fma_f16 v211, v203, v50, v211 op_sel:[0,0,0] op_sel_hi:[1,0,1] neg_lo:[0,0,1] neg_hi:[0,0,1]
    v_pk_fma_f16 v254, v234, v45, v254 op_sel:[0,1,0] op_sel_hi:[1,1,1] neg_lo:[1,0,0] neg_hi:[1,0,0]
    v_pk_fma_f16 v226, v202, v50, v226 op_sel:[0,1,0] op_sel_hi:[1,1,1]
    v_pk_fma_f16 v227, v203, v50, v227 op_sel:[0,1,0] op_sel_hi:[1,1,1]
    v_pk_mul_f16 v243, v253, v44 op_sel:[0,1] op_sel_hi:[1,1]
    v_pk_mul_f16 v212, v220, v50 op_sel:[0,1] op_sel_hi:[1,1]
    v_pk_mul_f16 v213, v221, v50 op_sel:[0,1] op_sel_hi:[1,1]
    v_pk_mul_f16 v255, v253, v44 op_sel:[0,0] op_sel_hi:[1,0]
    v_pk_mul_f16 v228, v220, v50 op_sel:[0,0] op_sel_hi:[1,0]
    v_pk_mul_f16 v229, v221, v50 op_sel:[0,0] op_sel_hi:[1,0]
    v_pk_fma_f16 v243, v241, v44, v243 op_sel:[0,0,0] op_sel_hi:[1,0,1]
    v_pk_fma_f16 v212, v204, v50, v212 op_sel:[0,0,0] op_sel_hi:[1,0,1] neg_lo:[0,0,1] neg_hi:[0,0,1]
    v_pk_fma_f16 v213, v205, v50, v213 op_sel:[0,0,0] op_sel_hi:[1,0,1] neg_lo:[0,0,1] neg_hi:[0,0,1]
    v_pk_fma_f16 v255, v241, v44, v255 op_sel:[0,1,0] op_sel_hi:[1,1,1] neg_lo:[1,0,0] neg_hi:[1,0,0]
    v_pk_fma_f16 v228, v204, v50, v228 op_sel:[0,1,0] op_sel_hi:[1,1,1]
    v_pk_fma_f16 v229, v205, v50, v229 op_sel:[0,1,0] op_sel_hi:[1,1,1]
    v_pk_mul_f16 v238, v253, v46 op_sel:[0,1] op_sel_hi:[1,1]
    v_pk_mul_f16 v214, v222, v50 op_sel:[0,1] op_sel_hi:[1,1]
    v_pk_mul_f16 v215, v223, v50 op_sel:[0,1] op_sel_hi:[1,1]
    v_pk_mul_f16 v250, v253, v46 op_sel:[0,0] op_sel_hi:[1,0]
    v_pk_mul_f16 v230, v222, v50 op_sel:[0,0] op_sel_hi:[1,0]
    v_pk_mul_f16 v231, v223, v50 op_sel:[0,0] op_sel_hi:[1,0]
    v_pk_fma_f16 v238, v241, v46, v238 op_sel:[0,0,0] op_sel_hi:[1,0,1]
    v_pk_fma_f16 v214, v206, v50, v214 op_sel:[0,0,0] op_sel_hi:[1,0,1] neg_lo:[0,0,1] neg_hi:[0,0,1]
    v_pk_fma_f16 v215, v207, v50, v215 op_sel:[0,0,0] op_sel_hi:[1,0,1] neg_lo:[0,0,1] neg_hi:[0,0,1]
    v_pk_fma_f16 v250, v241, v46, v250 op_sel:[0,1,0] op_sel_hi:[1,1,1] neg_lo:[1,0,0] neg_hi:[1,0,0]
    v_pk_fma_f16 v230, v206, v50, v230 op_sel:[0,1,0] op_sel_hi:[1,1,1]
    v_pk_fma_f16 v231, v207, v50, v231 op_sel:[0,1,0] op_sel_hi:[1,1,1]
    v_readfirstlane_b32 s79, v22
    v_and_b32 v18, 7, v1
    v_lshlrev_b32 v18, 4, v18
    s_cmp_lg_u32 s54, 1
    s_cbranch_scc1 Lnog0
    s_add_u32 s30, s17, 0
    s_cmp_ge_u32 s30, 10
    s_cselect_b32 s18, 10, 0
    s_sub_u32 s30, s30, s18
    s_lshl_b32 s30, s30, 7
    buffer_load_dwordx4 v[80:83], v18, s[72:75], s30 offen
    s_add_u32 s30, s17, 1
    s_cmp_ge_u32 s30, 10
    s_cselect_b32 s18, 10, 0
    s_sub_u32 s30, s30, s18
    s_lshl_b32 s30, s30, 7
    buffer_load_dwordx4 v[84:87], v18, s[72:75], s30 offen
Lnog0:
    s_setprio 1
    v_lshrrev_b32 v28, 3, v1
    s_lshl_b32 s28, s14, 10
    s_lshl_b32 s29, s14, 1
    s_and_b32 s29, s29, 4
    v_and_b32 v29, 7, v1
    v_lshrrev_b32 v13, 4, v1
    v_xor_b32 v13, v29, v13
    v_xor_b32 v13, s29, v13
    v_lshlrev_b32 v13, 4, v13
    v_lshl_add_u32 v13, v28, 7, v13
    v_add_u32 v13, s28, v13
    s_mov_b32 s50, 40992
    v_mov_b32 v14, 0
    v_mov_b32 v15, 0
    v_mov_b32 v16, 0
    v_mov_b32 v17, 0
    s_lshr_b32 s40, s14, 2
    v_lshrrev_b32 v32, 5, v1
    v_and_b32 v33, 1, v1
    v_lshl_add_u32 v32, v32, 1, v33
    v_lshlrev_b32 v32, 12, v32
    v_bfe_u32 v33, v1, 2, 2
    v_lshl_add_u32 v32, v33, 7, v32
    v_bfe_u32 v34, v1, 1, 1
    v_lshl_add_u32 v32, v34, 3, v32
    v_bfe_u32 v34, v1, 4, 1
    v_bfe_u32 v33, v1, 3, 1
    v_xor_b32 v33, v33, v34
    s_lshl_b32 s28, s40, 1
    v_xor_b32 v33, s28, v33
    v_lshl_add_u32 v8, v33, 4, v32
    v_xor_b32 v9, 32, v8
    v_add_u32 v9, 512, v9
    v_xor_b32 v10, 64, v8
    v_xor_b32 v11, 64, v9
    v_bfe_u32 v32, v1, 3, 2
    v_lshlrev_b32 v32, 14, v32
    v_and_b32 v33, 7, v1
    v_lshl_add_u32 v32, v33, 4, v32
    v_lshrrev_b32 v33, 5, v1
    v_lshl_add_u32 v12, v33, 7, v32
    s_mov_b32 s34, s17
    s_lshl_b32 s33, s40, 16
    s_lshl_b32 s28, s101, 8
    s_add_u32 s33, s33, s28
    s_add_u32 s33, s33, 8388608
    v_and_b32 v22, 15, v1
    v_lshlrev_b32 v22, 2, v22
    s_lshl_b32 s19, s16, 7
    s_add_u32 s19, s19, 14692352
    ds_write_b128 v2, v[88:91] offset:0
    ds_write_b128 v2, v[92:95] offset:16
    ds_write_b128 v2, v[96:99] offset:32
    ds_write_b128 v2, v[100:103] offset:48
    ds_write_b128 v2, v[120:123] offset:64
    ds_write_b128 v2, v[124:127] offset:80
    ds_write_b128 v2, v[128:131] offset:96
    ds_read_b64_tr_b16 v[32:33], v3 offset:64
    ds_read_b64_tr_b16 v[34:35], v3 offset:176
    ds_read_b64_tr_b16 v[36:37], v3 offset:0
    ds_read_b64_tr_b16 v[38:39], v3 offset:112
    ds_read_b64_tr_b16 v[40:41], v3 offset:1856
    ds_read_b64_tr_b16 v[42:43], v3 offset:1968
    ds_read_b64_tr_b16 v[44:45], v3 offset:1792
    ds_read_b64_tr_b16 v[46:47], v3 offset:1904
    ds_read_b64_tr_b16 v[48:49], v3 offset:3648
    ds_read_b64_tr_b16 v[50:51], v3 offset:3760
    ds_read_b64_tr_b16 v[52:53], v3 offset:3584
    ds_read_b64_tr_b16 v[54:55], v3 offset:3696
    ds_read_b64_tr_b16 v[56:57], v3 offset:5440
    ds_read_b64_tr_b16 v[58:59], v3 offset:5552
    ds_read_b64_tr_b16 v[60:61], v3 offset:5376
    ds_read_b64_tr_b16 v[62:63], v3 offset:5488
    s_waitcnt lgkmcnt(12)
    v_mfma_f32_32x32x16_f16 v[64:79], v[32:35], v[36:39], 0
    s_waitcnt lgkmcnt(8)
    v_mfma_f32_32x32x16_f16 v[64:79], v[40:43], v[44:47], v[64:79]
    s_waitcnt lgkmcnt(4)
    v_mfma_f32_32x32x16_f16 v[64:79], v[48:51], v[52:55], v[64:79]
    s_waitcnt lgkmcnt(0)
    v_mfma_f32_32x32x16_f16 v[64:79], v[56:59], v[60:63], v[64:79]
    s_barrier
    s_cmp_lg_u32 s54, 2
    s_cbranch_scc1 Lnou_55
    ds_read_b64_tr_b16 v[32:33], v8 offset:40992
    ds_read_b64_tr_b16 v[34:35], v9 offset:40992
    ds_read_b64_tr_b16 v[36:37], v8 offset:42016
    ds_read_b64_tr_b16 v[38:39], v9 offset:42016
    ds_read_b64_tr_b16 v[40:41], v10 offset:43040
    ds_read_b64_tr_b16 v[42:43], v11 offset:43040
    ds_read_b64_tr_b16 v[44:45], v10 offset:44064
    ds_read_b64_tr_b16 v[46:47], v11 offset:44064
    s_waitcnt lgkmcnt(0)
    s_mov_b32 vcc_lo, 0x55555555
    s_mov_b32 vcc_hi, 0x55555555
    v_cndmask_b32_dpp v48, v36, v32, vcc quad_perm:[1,0,3,2] row_mask:0xf bank_mask:0xf
    v_cndmask_b32_dpp v49, v37, v33, vcc quad_perm:[1,0,3,2] row_mask:0xf bank_mask:0xf
    v_cndmask_b32_dpp v50, v38, v34, vcc quad_perm:[1,0,3,2] row_mask:0xf bank_mask:0xf
    v_cndmask_b32_dpp v51, v39, v35, vcc quad_perm:[1,0,3,2] row_mask:0xf bank_mask:0xf
    v_cndmask_b32_dpp v56, v44, v40, vcc quad_perm:[1,0,3,2] row_mask:0xf bank_mask:0xf
    v_cndmask_b32_dpp v57, v45, v41, vcc quad_perm:[1,0,3,2] row_mask:0xf bank_mask:0xf
    v_cndmask_b32_dpp v58, v46, v42, vcc quad_perm:[1,0,3,2] row_mask:0xf bank_mask:0xf
    v_cndmask_b32_dpp v59, v47, v43, vcc quad_perm:[1,0,3,2] row_mask:0xf bank_mask:0xf
    s_mov_b32 vcc_lo, 0xaaaaaaaa
    s_mov_b32 vcc_hi, 0xaaaaaaaa
    v_cndmask_b32_dpp v52, v32, v36, vcc quad_perm:[1,0,3,2] row_mask:0xf bank_mask:0xf
    v_cndmask_b32_dpp v53, v33, v37, vcc quad_perm:[1,0,3,2] row_mask:0xf bank_mask:0xf
    v_cndmask_b32_dpp v54, v34, v38, vcc quad_perm:[1,0,3,2] row_mask:0xf bank_mask:0xf
    v_cndmask_b32_dpp v55, v35, v39, vcc quad_perm:[1,0,3,2] row_mask:0xf bank_mask:0xf
    v_cndmask_b32_dpp v60, v40, v44, vcc quad_perm:[1,0,3,2] row_mask:0xf bank_mask:0xf
    v_cndmask_b32_dpp v61, v41, v45, vcc quad_perm:[1,0,3,2] row_mask:0xf bank_mask:0xf
    v_cndmask_b32_dpp v62, v42, v46, vcc quad_perm:[1,0,3,2] row_mask:0xf bank_mask:0xf
    v_cndmask_b32_dpp v63, v43, v47, vcc quad_perm:[1,0,3,2] row_mask:0xf bank_mask:0xf
    s_mov_b32 vcc_lo, 0x33333333
    s_mov_b32 vcc_hi, 0x33333333
    v_cndmask_b32_dpp v32, v56, v48, vcc quad_perm:[2,3,0,1] row_mask:0xf bank_mask:0xf
    v_cndmask_b32_dpp v33, v57, v49, vcc quad_perm:[2,3,0,1] row_mask:0xf bank_mask:0xf
    v_cndmask_b32_dpp v34, v58, v50, vcc quad_perm:[2,3,0,1] row_mask:0xf bank_mask:0xf
    v_cndmask_b32_dpp v35, v59, v51, vcc quad_perm:[2,3,0,1] row_mask:0xf bank_mask:0xf
    v_cndmask_b32_dpp v36, v60, v52, vcc quad_perm:[2,3,0,1] row_mask:0xf bank_mask:0xf
    v_cndmask_b32_dpp v37, v61, v53, vcc quad_perm:[2,3,0,1] row_mask:0xf bank_mask:0xf
    v_cndmask_b32_dpp v38, v62, v54, vcc quad_perm:[2,3,0,1] row_mask:0xf bank_mask:0xf
    v_cndmask_b32_dpp v39, v63, v55, vcc quad_perm:[2,3,0,1] row_mask:0xf bank_mask:0xf
    s_mov_b32 vcc_lo, 0xcccccccc
    s_mov_b32 vcc_hi, 0xcccccccc
    v_cndmask_b32_dpp v40, v48, v56, vcc quad_perm:[2,3,0,1] row_mask:0xf bank_mask:0xf
    v_cndmask_b32_dpp v41, v49, v57, vcc quad_perm:[2,3,0,1] row_mask:0xf bank_mask:0xf
    v_cndmask_b32_dpp v42, v50, v58, vcc quad_perm:[2,3,0,1] row_mask:0xf bank_mask:0xf
    v_cndmask_b32_dpp v43, v51, v59, vcc quad_perm:[2,3,0,1] row_mask:0xf bank_mask:0xf
    v_cndmask_b32_dpp v44, v52, v60, vcc quad_perm:[2,3,0,1] row_mask:0xf bank_mask:0xf
    v_cndmask_b32_dpp v45, v53, v61, vcc quad_perm:[2,3,0,1] row_mask:0xf bank_mask:0xf
    v_cndmask_b32_dpp v46, v54, v62, vcc quad_perm:[2,3,0,1] row_mask:0xf bank_mask:0xf
    v_cndmask_b32_dpp v47, v55, v63, vcc quad_perm:[2,3,0,1] row_mask:0xf bank_mask:0xf
    s_lshl_b32 s51, s34, 18
    s_add_u32 s51, s51, s33
    s_add_u32 s34, s34, 1
    s_cmp_eq_u32 s34, 10
    s_cselect_b32 s34, 0, s34
    s_add_u32 s35, s51, 0
    buffer_store_dwordx4 v[32:35], v12, s[8:11], s35 offen sc1
    s_add_u32 s35, s51, 4096
    buffer_store_dwordx4 v[36:39], v12, s[8:11], s35 offen sc1
    s_add_u32 s35, s51, 8192
    buffer_store_dwordx4 v[40:43], v12, s[8:11], s35 offen sc1
    s_add_u32 s35, s51, 12288
    buffer_store_dwordx4 v[44:47], v12, s[8:11], s35 offen sc1
Lnou_55:
    s_cmp_lg_u32 s54, 1
    s_cbranch_scc1 Lnog_56
    v_add_u32 v28, s50, v13
    s_add_u32 s50, s50, 40992
    ds_read_b128 v[24:27], v28
    s_cmp_eq_u32 s50, 122976
    s_cselect_b32 s50, 0, s50
    s_waitcnt vmcnt(0)
    s_waitcnt lgkmcnt(0)
    v_dot2c_f32_bf16 v14, v80, v24
    v_dot2c_f32_bf16 v15, v81, v25
    v_dot2c_f32_bf16 v16, v82, v26
    v_dot2c_f32_bf16 v17, v83, v27
Lnog_56:
    ds_write_b128 v2, v[104:107] offset:0
    ds_write_b128 v2, v[108:111] offset:16
    ds_write_b128 v2, v[112:115] offset:32
    ds_write_b128 v2, v[116:119] offset:48
    ds_write_b128 v2, v[132:135] offset:64
    ds_write_b128 v2, v[136:139] offset:80
    ds_write_b128 v2, v[140:143] offset:96
    ds_read_b64_tr_b16 v[32:33], v3 offset:64
    ds_read_b64_tr_b16 v[34:35], v3 offset:176
    ds_read_b64_tr_b16 v[36:37], v3 offset:0
    ds_read_b64_tr_b16 v[38:39], v3 offset:112
    ds_read_b64_tr_b16 v[40:41], v3 offset:1856
    ds_read_b64_tr_b16 v[42:43], v3 offset:1968
    ds_read_b64_tr_b16 v[44:45], v3 offset:1792
    ds_read_b64_tr_b16 v[46:47], v3 offset:1904
    ds_read_b64_tr_b16 v[48:49], v3 offset:3648
    ds_read_b64_tr_b16 v[50:51], v3 offset:3760
    ds_read_b64_tr_b16 v[52:53], v3 offset:3584
    ds_read_b64_tr_b16 v[54:55], v3 offset:3696
    ds_read_b64_tr_b16 v[56:57], v3 offset:5440
    ds_read_b64_tr_b16 v[58:59], v3 offset:5552
    ds_read_b64_tr_b16 v[60:61], v3 offset:5376
    ds_read_b64_tr_b16 v[62:63], v3 offset:5488
    s_waitcnt lgkmcnt(12)
    v_mfma_f32_32x32x16_f16 v[64:79], v[32:35], v[36:39], v[64:79]
    s_waitcnt lgkmcnt(8)
    v_mfma_f32_32x32x16_f16 v[64:79], v[40:43], v[44:47], v[64:79]
    s_waitcnt lgkmcnt(4)
    v_mfma_f32_32x32x16_f16 v[64:79], v[48:51], v[52:55], v[64:79]
    s_waitcnt lgkmcnt(0)
    v_mfma_f32_32x32x16_f16 v[64:79], v[56:59], v[60:63], v[64:79]
    s_cmp_lg_u32 s54, 1
    s_cbranch_scc1 Lnog_57
    s_add_u32 s30, s17, 2
    s_cmp_ge_u32 s30, 10
    s_cselect_b32 s18, 10, 0
    s_sub_u32 s30, s30, s18
    s_lshl_b32 s30, s30, 7
    buffer_load_dwordx4 v[88:91], v18, s[72:75], s30 offen
    s_add_u32 s30, s17, 3
    s_cmp_ge_u32 s30, 10
    s_cselect_b32 s18, 10, 0
    s_sub_u32 s30, s30, s18
    s_lshl_b32 s30, s30, 7
    buffer_load_dwordx4 v[92:95], v18, s[72:75], s30 offen
    s_add_u32 s30, s17, 4
    s_cmp_ge_u32 s30, 10
    s_cselect_b32 s18, 10, 0
    s_sub_u32 s30, s30, s18
    s_lshl_b32 s30, s30, 7
    buffer_load_dwordx4 v[96:99], v18, s[72:75], s30 offen
    s_add_u32 s30, s17, 5
    s_cmp_ge_u32 s30, 10
    s_cselect_b32 s18, 10, 0
    s_sub_u32 s30, s30, s18
    s_lshl_b32 s30, s30, 7
    buffer_load_dwordx4 v[100:103], v18, s[72:75], s30 offen
    s_add_u32 s30, s17, 6
    s_cmp_ge_u32 s30, 10
    s_cselect_b32 s18, 10, 0
    s_sub_u32 s30, s30, s18
    s_lshl_b32 s30, s30, 7
    buffer_load_dwordx4 v[104:107], v18, s[72:75], s30 offen
    s_add_u32 s30, s17, 7
    s_cmp_ge_u32 s30, 10
    s_cselect_b32 s18, 10, 0
    s_sub_u32 s30, s30, s18
    s_lshl_b32 s30, s30, 7
    buffer_load_dwordx4 v[108:111], v18, s[72:75], s30 offen
Lnog_57:
    s_barrier
    s_cmp_lg_u32 s54, 2
    s_cbranch_scc1 Lnou_58
    v_add_u32 v28, 81984, v8
    v_add_u32 v29, 81984, v9
    v_add_u32 v30, 81984, v10
    v_add_u32 v31, 81984, v11
    ds_read_b64_tr_b16 v[32:33], v28 offset:0
    ds_read_b64_tr_b16 v[34:35], v29 offset:0
    ds_read_b64_tr_b16 v[36:37], v28 offset:1024
    ds_read_b64_tr_b16 v[38:39], v29 offset:1024
    ds_read_b64_tr_b16 v[40:41], v30 offset:2048
    ds_read_b64_tr_b16 v[42:43], v31 offset:2048
    ds_read_b64_tr_b16 v[44:45], v30 offset:3072
    ds_read_b64_tr_b16 v[46:47], v31 offset:3072
    s_waitcnt lgkmcnt(0)
    s_mov_b32 vcc_lo, 0x55555555
    s_mov_b32 vcc_hi, 0x55555555
    v_cndmask_b32_dpp v48, v36, v32, vcc quad_perm:[1,0,3,2] row_mask:0xf bank_mask:0xf
    v_cndmask_b32_dpp v49, v37, v33, vcc quad_perm:[1,0,3,2] row_mask:0xf bank_mask:0xf
    v_cndmask_b32_dpp v50, v38, v34, vcc quad_perm:[1,0,3,2] row_mask:0xf bank_mask:0xf
    v_cndmask_b32_dpp v51, v39, v35, vcc quad_perm:[1,0,3,2] row_mask:0xf bank_mask:0xf
    v_cndmask_b32_dpp v56, v44, v40, vcc quad_perm:[1,0,3,2] row_mask:0xf bank_mask:0xf
    v_cndmask_b32_dpp v57, v45, v41, vcc quad_perm:[1,0,3,2] row_mask:0xf bank_mask:0xf
    v_cndmask_b32_dpp v58, v46, v42, vcc quad_perm:[1,0,3,2] row_mask:0xf bank_mask:0xf
    v_cndmask_b32_dpp v59, v47, v43, vcc quad_perm:[1,0,3,2] row_mask:0xf bank_mask:0xf
    s_mov_b32 vcc_lo, 0xaaaaaaaa
    s_mov_b32 vcc_hi, 0xaaaaaaaa
    v_cndmask_b32_dpp v52, v32, v36, vcc quad_perm:[1,0,3,2] row_mask:0xf bank_mask:0xf
    v_cndmask_b32_dpp v53, v33, v37, vcc quad_perm:[1,0,3,2] row_mask:0xf bank_mask:0xf
    v_cndmask_b32_dpp v54, v34, v38, vcc quad_perm:[1,0,3,2] row_mask:0xf bank_mask:0xf
    v_cndmask_b32_dpp v55, v35, v39, vcc quad_perm:[1,0,3,2] row_mask:0xf bank_mask:0xf
    v_cndmask_b32_dpp v60, v40, v44, vcc quad_perm:[1,0,3,2] row_mask:0xf bank_mask:0xf
    v_cndmask_b32_dpp v61, v41, v45, vcc quad_perm:[1,0,3,2] row_mask:0xf bank_mask:0xf
    v_cndmask_b32_dpp v62, v42, v46, vcc quad_perm:[1,0,3,2] row_mask:0xf bank_mask:0xf
    v_cndmask_b32_dpp v63, v43, v47, vcc quad_perm:[1,0,3,2] row_mask:0xf bank_mask:0xf
    s_mov_b32 vcc_lo, 0x33333333
    s_mov_b32 vcc_hi, 0x33333333
    v_cndmask_b32_dpp v32, v56, v48, vcc quad_perm:[2,3,0,1] row_mask:0xf bank_mask:0xf
    v_cndmask_b32_dpp v33, v57, v49, vcc quad_perm:[2,3,0,1] row_mask:0xf bank_mask:0xf
    v_cndmask_b32_dpp v34, v58, v50, vcc quad_perm:[2,3,0,1] row_mask:0xf bank_mask:0xf
    v_cndmask_b32_dpp v35, v59, v51, vcc quad_perm:[2,3,0,1] row_mask:0xf bank_mask:0xf
    v_cndmask_b32_dpp v36, v60, v52, vcc quad_perm:[2,3,0,1] row_mask:0xf bank_mask:0xf
    v_cndmask_b32_dpp v37, v61, v53, vcc quad_perm:[2,3,0,1] row_mask:0xf bank_mask:0xf
    v_cndmask_b32_dpp v38, v62, v54, vcc quad_perm:[2,3,0,1] row_mask:0xf bank_mask:0xf
    v_cndmask_b32_dpp v39, v63, v55, vcc quad_perm:[2,3,0,1] row_mask:0xf bank_mask:0xf
    s_mov_b32 vcc_lo, 0xcccccccc
    s_mov_b32 vcc_hi, 0xcccccccc
    v_cndmask_b32_dpp v40, v48, v56, vcc quad_perm:[2,3,0,1] row_mask:0xf bank_mask:0xf
    v_cndmask_b32_dpp v41, v49, v57, vcc quad_perm:[2,3,0,1] row_mask:0xf bank_mask:0xf
    v_cndmask_b32_dpp v42, v50, v58, vcc quad_perm:[2,3,0,1] row_mask:0xf bank_mask:0xf
    v_cndmask_b32_dpp v43, v51, v59, vcc quad_perm:[2,3,0,1] row_mask:0xf bank_mask:0xf
    v_cndmask_b32_dpp v44, v52, v60, vcc quad_perm:[2,3,0,1] row_mask:0xf bank_mask:0xf
    v_cndmask_b32_dpp v45, v53, v61, vcc quad_perm:[2,3,0,1] row_mask:0xf bank_mask:0xf
    v_cndmask_b32_dpp v46, v54, v62, vcc quad_perm:[2,3,0,1] row_mask:0xf bank_mask:0xf
    v_cndmask_b32_dpp v47, v55, v63, vcc quad_perm:[2,3,0,1] row_mask:0xf bank_mask:0xf
    s_lshl_b32 s51, s34, 18
    s_add_u32 s51, s51, s33
    s_add_u32 s34, s34, 1
    s_cmp_eq_u32 s34, 10
    s_cselect_b32 s34, 0, s34
    s_add_u32 s35, s51, 0
    buffer_store_dwordx4 v[32:35], v12, s[8:11], s35 offen sc1
    s_add_u32 s35, s51, 4096
    buffer_store_dwordx4 v[36:39], v12, s[8:11], s35 offen sc1
    s_add_u32 s35, s51, 8192
    buffer_store_dwordx4 v[40:43], v12, s[8:11], s35 offen sc1
    s_add_u32 s35, s51, 12288
    buffer_store_dwordx4 v[44:47], v12, s[8:11], s35 offen sc1
Lnou_58:
    s_cmp_lg_u32 s54, 1
    s_cbranch_scc1 Lnog_59
    v_add_u32 v28, s50, v13
    s_add_u32 s50, s50, 40992
    ds_read_b128 v[24:27], v28
    s_cmp_eq_u32 s50, 122976
    s_cselect_b32 s50, 0, s50
    s_waitcnt lgkmcnt(0)
    v_dot2c_f32_bf16 v14, v84, v24
    v_dot2c_f32_bf16 v15, v85, v25
    v_dot2c_f32_bf16 v16, v86, v26
    v_dot2c_f32_bf16 v17, v87, v27
Lnog_59:
    s_barrier
    s_cmp_lg_u32 s54, 2
    s_cbranch_scc1 Lnou_60
    ds_read_b64_tr_b16 v[32:33], v8 offset:0
    ds_read_b64_tr_b16 v[34:35], v9 offset:0
    ds_read_b64_tr_b16 v[36:37], v8 offset:1024
    ds_read_b64_tr_b16 v[38:39], v9 offset:1024
    ds_read_b64_tr_b16 v[40:41], v10 offset:2048
    ds_read_b64_tr_b16 v[42:43], v11 offset:2048
    ds_read_b64_tr_b16 v[44:45], v10 offset:3072
    ds_read_b64_tr_b16 v[46:47], v11 offset:3072
    s_waitcnt lgkmcnt(0)
    s_mov_b32 vcc_lo, 0x55555555
    s_mov_b32 vcc_hi, 0x55555555
    v_cndmask_b32_dpp v48, v36, v32, vcc quad_perm:[1,0,3,2] row_mask:0xf bank_mask:0xf
    v_cndmask_b32_dpp v49, v37, v33, vcc quad_perm:[1,0,3,2] row_mask:0xf bank_mask:0xf
    v_cndmask_b32_dpp v50, v38, v34, vcc quad_perm:[1,0,3,2] row_mask:0xf bank_mask:0xf
    v_cndmask_b32_dpp v51, v39, v35, vcc quad_perm:[1,0,3,2] row_mask:0xf bank_mask:0xf
    v_cndmask_b32_dpp v56, v44, v40, vcc quad_perm:[1,0,3,2] row_mask:0xf bank_mask:0xf
    v_cndmask_b32_dpp v57, v45, v41, vcc quad_perm:[1,0,3,2] row_mask:0xf bank_mask:0xf
    v_cndmask_b32_dpp v58, v46, v42, vcc quad_perm:[1,0,3,2] row_mask:0xf bank_mask:0xf
    v_cndmask_b32_dpp v59, v47, v43, vcc quad_perm:[1,0,3,2] row_mask:0xf bank_mask:0xf
    s_mov_b32 vcc_lo, 0xaaaaaaaa
    s_mov_b32 vcc_hi, 0xaaaaaaaa
    v_cndmask_b32_dpp v52, v32, v36, vcc quad_perm:[1,0,3,2] row_mask:0xf bank_mask:0xf
    v_cndmask_b32_dpp v53, v33, v37, vcc quad_perm:[1,0,3,2] row_mask:0xf bank_mask:0xf
    v_cndmask_b32_dpp v54, v34, v38, vcc quad_perm:[1,0,3,2] row_mask:0xf bank_mask:0xf
    v_cndmask_b32_dpp v55, v35, v39, vcc quad_perm:[1,0,3,2] row_mask:0xf bank_mask:0xf
    v_cndmask_b32_dpp v60, v40, v44, vcc quad_perm:[1,0,3,2] row_mask:0xf bank_mask:0xf
    v_cndmask_b32_dpp v61, v41, v45, vcc quad_perm:[1,0,3,2] row_mask:0xf bank_mask:0xf
    v_cndmask_b32_dpp v62, v42, v46, vcc quad_perm:[1,0,3,2] row_mask:0xf bank_mask:0xf
    v_cndmask_b32_dpp v63, v43, v47, vcc quad_perm:[1,0,3,2] row_mask:0xf bank_mask:0xf
    s_mov_b32 vcc_lo, 0x33333333
    s_mov_b32 vcc_hi, 0x33333333
    v_cndmask_b32_dpp v32, v56, v48, vcc quad_perm:[2,3,0,1] row_mask:0xf bank_mask:0xf
    v_cndmask_b32_dpp v33, v57, v49, vcc quad_perm:[2,3,0,1] row_mask:0xf bank_mask:0xf
    v_cndmask_b32_dpp v34, v58, v50, vcc quad_perm:[2,3,0,1] row_mask:0xf bank_mask:0xf
    v_cndmask_b32_dpp v35, v59, v51, vcc quad_perm:[2,3,0,1] row_mask:0xf bank_mask:0xf
    v_cndmask_b32_dpp v36, v60, v52, vcc quad_perm:[2,3,0,1] row_mask:0xf bank_mask:0xf
    v_cndmask_b32_dpp v37, v61, v53, vcc quad_perm:[2,3,0,1] row_mask:0xf bank_mask:0xf
    v_cndmask_b32_dpp v38, v62, v54, vcc quad_perm:[2,3,0,1] row_mask:0xf bank_mask:0xf
    v_cndmask_b32_dpp v39, v63, v55, vcc quad_perm:[2,3,0,1] row_mask:0xf bank_mask:0xf
    s_mov_b32 vcc_lo, 0xcccccccc
    s_mov_b32 vcc_hi, 0xcccccccc
    v_cndmask_b32_dpp v40, v48, v56, vcc quad_perm:[2,3,0,1] row_mask:0xf bank_mask:0xf
    v_cndmask_b32_dpp v41, v49, v57, vcc quad_perm:[2,3,0,1] row_mask:0xf bank_mask:0xf
    v_cndmask_b32_dpp v42, v50, v58, vcc quad_perm:[2,3,0,1] row_mask:0xf bank_mask:0xf
    v_cndmask_b32_dpp v43, v51, v59, vcc quad_perm:[2,3,0,1] row_mask:0xf bank_mask:0xf
    v_cndmask_b32_dpp v44, v52, v60, vcc quad_perm:[2,3,0,1] row_mask:0xf bank_mask:0xf
    v_cndmask_b32_dpp v45, v53, v61, vcc quad_perm:[2,3,0,1] row_mask:0xf bank_mask:0xf
    v_cndmask_b32_dpp v46, v54, v62, vcc quad_perm:[2,3,0,1] row_mask:0xf bank_mask:0xf
    v_cndmask_b32_dpp v47, v55, v63, vcc quad_perm:[2,3,0,1] row_mask:0xf bank_mask:0xf
    s_lshl_b32 s51, s34, 18
    s_add_u32 s51, s51, s33
    s_add_u32 s34, s34, 1
    s_cmp_eq_u32 s34, 10
    s_cselect_b32 s34, 0, s34
    s_add_u32 s35, s51, 0
    buffer_store_dwordx4 v[32:35], v12, s[8:11], s35 offen sc1
    s_add_u32 s35, s51, 4096
    buffer_store_dwordx4 v[36:39], v12, s[8:11], s35 offen sc1
    s_add_u32 s35, s51, 8192
    buffer_store_dwordx4 v[40:43], v12, s[8:11], s35 offen sc1
    s_add_u32 s35, s51, 12288
    buffer_store_dwordx4 v[44:47], v12, s[8:11], s35 offen sc1
Lnou_60:
    s_cmp_lg_u32 s54, 1
    s_cbranch_scc1 Lnog_61
    v_add_u32 v28, s50, v13
    s_add_u32 s50, s50, 40992
    ds_read_b128 v[24:27], v28
    s_cmp_eq_u32 s50, 122976
    s_cselect_b32 s50, 0, s50
    s_waitcnt vmcnt(0)
    s_waitcnt lgkmcnt(0)
    v_dot2c_f32_bf16 v14, v88, v24
    v_dot2c_f32_bf16 v15, v89, v25
    v_dot2c_f32_bf16 v16, v90, v26
    v_dot2c_f32_bf16 v17, v91, v27
Lnog_61:
    s_barrier
    s_cmp_lg_u32 s54, 2
    s_cbranch_scc1 Lnou_62
    v_add_u32 v28, s17, v1
    v_add_u32 v29, -10, v28
    v_min_u32 v28, v28, v29
    v_lshlrev_b32 v28, 8, v28
    v_mov_b32 v29, s12
    s_lshl_b32 s28, s40, 6
    s_lshl_b32 s29, s101, 2
    s_add_u32 s28, s28, s29
    s_add_u32 s28, s28, 14688256
    s_waitcnt vmcnt(0)
    s_mov_b64 exec, 7
    buffer_store_dword v29, v28, s[8:11], s28 offen sc1
    s_mov_b64 exec, -1
Lnou_62:
    s_cmp_lg_u32 s54, 1
    s_cbranch_scc1 Lnog_63
    v_add_u32 v28, s50, v13
    s_add_u32 s50, s50, 40992
    ds_read_b128 v[24:27], v28
    s_cmp_eq_u32 s50, 122976
    s_cselect_b32 s50, 0, s50
    s_waitcnt lgkmcnt(0)
    v_dot2c_f32_bf16 v14, v92, v24
    v_dot2c_f32_bf16 v15, v93, v25
    v_dot2c_f32_bf16 v16, v94, v26
    v_dot2c_f32_bf16 v17, v95, v27
Lnog_63:
    s_barrier
    s_cmp_lg_u32 s54, 1
    s_cbranch_scc1 Lnog_64
    v_add_u32 v28, s50, v13
    s_add_u32 s50, s50, 40992
    ds_read_b128 v[24:27], v28
    s_cmp_eq_u32 s50, 122976
    s_cselect_b32 s50, 0, s50
    s_waitcnt lgkmcnt(0)
    v_dot2c_f32_bf16 v14, v96, v24
    v_dot2c_f32_bf16 v15, v97, v25
    v_dot2c_f32_bf16 v16, v98, v26
    v_dot2c_f32_bf16 v17, v99, v27
Lnog_64:
    s_barrier
    s_cmp_lg_u32 s54, 1
    s_cbranch_scc1 Lnog_65
    v_add_u32 v28, s50, v13
    s_add_u32 s50, s50, 40992
    ds_read_b128 v[24:27], v28
    s_cmp_eq_u32 s50, 122976
    s_cselect_b32 s50, 0, s50
    s_waitcnt lgkmcnt(0)
    v_dot2c_f32_bf16 v14, v100, v24
    v_dot2c_f32_bf16 v15, v101, v25
    v_dot2c_f32_bf16 v16, v102, v26
    v_dot2c_f32_bf16 v17, v103, v27
Lnog_65:
    s_barrier
    s_cmp_lg_u32 s54, 1
    s_cbranch_scc1 Lnog_66
    v_add_u32 v28, s50, v13
    s_add_u32 s50, s50, 40992
    ds_read_b128 v[24:27], v28
    s_cmp_eq_u32 s50, 122976
    s_cselect_b32 s50, 0, s50
    s_waitcnt lgkmcnt(0)
    v_dot2c_f32_bf16 v14, v104, v24
    v_dot2c_f32_bf16 v15, v105, v25
    v_dot2c_f32_bf16 v16, v106, v26
    v_dot2c_f32_bf16 v17, v107, v27
Lnog_66:
    s_barrier
    s_cmp_lg_u32 s54, 1
    s_cbranch_scc1 Lnog_67
    v_add_u32 v28, s50, v13
    s_add_u32 s50, s50, 40992
    ds_read_b128 v[24:27], v28
    s_cmp_eq_u32 s50, 122976
    s_cselect_b32 s50, 0, s50
    s_waitcnt lgkmcnt(0)
    v_dot2c_f32_bf16 v14, v108, v24
    v_dot2c_f32_bf16 v15, v109, v25
    v_dot2c_f32_bf16 v16, v110, v26
    v_dot2c_f32_bf16 v17, v111, v27
    s_nop 0
    v_add_f32 v14, v14, v15
    s_nop 0
    v_add_f32 v16, v16, v17
    v_add_f32 v14, v14, v16
    s_nop 1
    v_add_f32_dpp v14, v14, v14 quad_perm:[1,0,3,2] row_mask:0xf bank_mask:0xf
    s_nop 1
    v_add_f32_dpp v14, v14, v14 quad_perm:[2,3,0,1] row_mask:0xf bank_mask:0xf
    s_nop 1
    v_add_f32_dpp v14, v14, v14 row_half_mirror row_mask:0xf bank_mask:0xf
    v_lshrrev_b32 v60, 3, v1
    v_lshl_add_u32 v60, v60, 2, v7
    s_mov_b32 exec_lo, 0x01010101
    s_mov_b32 exec_hi, 0x01010101
    ds_write_b32 v60, v14 offset:96
    s_mov_b64 exec, -1
    s_waitcnt lgkmcnt(0)
Lnog_67:
    s_load_dwordx16 s[20:35], s[8:9], s76 offset:0
    s_barrier
    s_waitcnt lgkmcnt(0)
    s_xor_b64 s[20:21], s[20:21], s[12:13]
    s_xor_b64 s[22:23], s[22:23], s[12:13]
    s_xor_b64 s[24:25], s[24:25], s[12:13]
    s_xor_b64 s[26:27], s[26:27], s[12:13]
    s_xor_b64 s[28:29], s[28:29], s[12:13]
    s_xor_b64 s[30:31], s[30:31], s[12:13]
    s_xor_b64 s[32:33], s[32:33], s[12:13]
    s_xor_b64 s[34:35], s[34:35], s[12:13]
    s_or_b64 s[20:21], s[20:21], s[22:23]
    s_or_b64 s[24:25], s[24:25], s[26:27]
    s_or_b64 s[28:29], s[28:29], s[30:31]
    s_or_b64 s[32:33], s[32:33], s[34:35]
    s_or_b64 s[20:21], s[20:21], s[24:25]
    s_or_b64 s[28:29], s[28:29], s[32:33]
    s_or_b64 s[20:21], s[20:21], s[28:29]
    s_cbranch_scc0 Lsc_68
    s_mov_b32 s18, 0
Lf_69:
    buffer_load_dword v24, v22, s[8:11], s76 offen sc1
    s_waitcnt vmcnt(0)
    v_cmp_ne_u32 vcc, s12, v24
    s_cbranch_vccz Lfd_70
    s_sleep 8
    s_add_u32 s18, s18, 1
    s_cmp_lt_u32 s18, 16384
    s_cbranch_scc1 Lf_69
Lfd_70:
Lsc_68:
    s_add_u32 m0, s52, 8800
    s_nop 0
    buffer_load_dwordx4 v6, s[8:11], s77 offen offset:0 sc1 lds
    buffer_load_dwordx4 v6, s[8:11], s77 offen offset:1024 sc1 lds
    buffer_load_dwordx4 v6, s[8:11], s77 offen offset:2048 sc1 lds
    buffer_load_dwordx4 v6, s[8:11], s77 offen offset:3072 sc1 lds
    ds_write_b128 v2, v[144:147] offset:0
    ds_write_b128 v2, v[148:151] offset:16
    ds_write_b128 v2, v[152:155] offset:32
    ds_write_b128 v2, v[156:159] offset:48
    ds_write_b128 v2, v[176:179] offset:64
    ds_write_b128 v2, v[180:183] offset:80
    ds_write_b128 v2, v[184:187] offset:96
    ds_read_b64_tr_b16 v[32:33], v3 offset:64
    ds_read_b64_tr_b16 v[34:35], v3 offset:176
    ds_read_b64_tr_b16 v[36:37], v3 offset:0
    ds_read_b64_tr_b16 v[38:39], v3 offset:112
    ds_read_b64_tr_b16 v[40:41], v3 offset:1856
    ds_read_b64_tr_b16 v[42:43], v3 offset:1968
    ds_read_b64_tr_b16 v[44:45], v3 offset:1792
    ds_read_b64_tr_b16 v[46:47], v3 offset:1904
    ds_read_b64_tr_b16 v[48:49], v3 offset:3648
    ds_read_b64_tr_b16 v[50:51], v3 offset:3760
    ds_read_b64_tr_b16 v[52:53], v3 offset:3584
    ds_read_b64_tr_b16 v[54:55], v3 offset:3696
    ds_read_b64_tr_b16 v[56:57], v3 offset:5440
    ds_read_b64_tr_b16 v[58:59], v3 offset:5552
    ds_read_b64_tr_b16 v[60:61], v3 offset:5376
    ds_read_b64_tr_b16 v[62:63], v3 offset:5488
    s_waitcnt lgkmcnt(12)
    v_mfma_f32_32x32x16_f16 v[64:79], v[32:35], v[36:39], v[64:79]
    s_waitcnt lgkmcnt(8)
    v_mfma_f32_32x32x16_f16 v[64:79], v[40:43], v[44:47], v[64:79]
    s_waitcnt lgkmcnt(4)
    v_mfma_f32_32x32x16_f16 v[64:79], v[48:51], v[52:55], v[64:79]
    s_waitcnt lgkmcnt(0)
    v_mfma_f32_32x32x16_f16 v[64:79], v[56:59], v[60:63], v[64:79]
    ds_write_b128 v2, v[160:163] offset:0
    ds_write_b128 v2, v[164:167] offset:16
    ds_write_b128 v2, v[168:171] offset:32
    ds_write_b128 v2, v[172:175] offset:48
    ds_write_b128 v2, v[188:191] offset:64
    ds_write_b128 v2, v[192:195] offset:80
    ds_write_b128 v2, v[196:199] offset:96
    ds_read_b64_tr_b16 v[32:33], v3 offset:64
    ds_read_b64_tr_b16 v[34:35], v3 offset:176
    ds_read_b64_tr_b16 v[36:37], v3 offset:0
    ds_read_b64_tr_b16 v[38:39], v3 offset:112
    ds_read_b64_tr_b16 v[40:41], v3 offset:1856
    ds_read_b64_tr_b16 v[42:43], v3 offset:1968
    ds_read_b64_tr_b16 v[44:45], v3 offset:1792
    ds_read_b64_tr_b16 v[46:47], v3 offset:1904
    ds_read_b64_tr_b16 v[48:49], v3 offset:3648
    ds_read_b64_tr_b16 v[50:51], v3 offset:3760
    ds_read_b64_tr_b16 v[52:53], v3 offset:3584
    ds_read_b64_tr_b16 v[54:55], v3 offset:3696
    ds_read_b64_tr_b16 v[56:57], v3 offset:5440
    ds_read_b64_tr_b16 v[58:59], v3 offset:5552
    ds_read_b64_tr_b16 v[60:61], v3 offset:5376
    ds_read_b64_tr_b16 v[62:63], v3 offset:5488
    s_waitcnt lgkmcnt(12)
    v_mfma_f32_32x32x16_f16 v[64:79], v[32:35], v[36:39], v[64:79]
    s_waitcnt lgkmcnt(8)
    v_mfma_f32_32x32x16_f16 v[64:79], v[40:43], v[44:47], v[64:79]
    s_waitcnt lgkmcnt(4)
    v_mfma_f32_32x32x16_f16 v[64:79], v[48:51], v[52:55], v[64:79]
    s_waitcnt lgkmcnt(0)
    v_mfma_f32_32x32x16_f16 v[64:79], v[56:59], v[60:63], v[64:79]
    ds_write_b128 v2, v[200:203] offset:0
    ds_write_b128 v2, v[204:207] offset:16
    ds_write_b128 v2, v[208:211] offset:32
    ds_write_b128 v2, v[212:215] offset:48
    ds_write_b128 v2, v[232:235] offset:64
    ds_write_b128 v2, v[236:239] offset:80
    ds_write_b128 v2, v[240:243] offset:96
    ds_read_b64_tr_b16 v[32:33], v3 offset:64
    ds_read_b64_tr_b16 v[34:35], v3 offset:176
    ds_read_b64_tr_b16 v[36:37], v3 offset:0
    ds_read_b64_tr_b16 v[38:39], v3 offset:112
    ds_read_b64_tr_b16 v[40:41], v3 offset:1856
    ds_read_b64_tr_b16 v[42:43], v3 offset:1968
    ds_read_b64_tr_b16 v[44:45], v3 offset:1792
    ds_read_b64_tr_b16 v[46:47], v3 offset:1904
    ds_read_b64_tr_b16 v[48:49], v3 offset:3648
    ds_read_b64_tr_b16 v[50:51], v3 offset:3760
    ds_read_b64_tr_b16 v[52:53], v3 offset:3584
    ds_read_b64_tr_b16 v[54:55], v3 offset:3696
    ds_read_b64_tr_b16 v[56:57], v3 offset:5440
    ds_read_b64_tr_b16 v[58:59], v3 offset:5552
    ds_read_b64_tr_b16 v[60:61], v3 offset:5376
    ds_read_b64_tr_b16 v[62:63], v3 offset:5488
    s_waitcnt lgkmcnt(12)
    v_mfma_f32_32x32x16_f16 v[64:79], v[32:35], v[36:39], v[64:79]
    s_waitcnt lgkmcnt(8)
    v_mfma_f32_32x32x16_f16 v[64:79], v[40:43], v[44:47], v[64:79]
    s_waitcnt lgkmcnt(4)
    v_mfma_f32_32x32x16_f16 v[64:79], v[48:51], v[52:55], v[64:79]
    s_waitcnt lgkmcnt(0)
    v_mfma_f32_32x32x16_f16 v[64:79], v[56:59], v[60:63], v[64:79]
    ds_write_b128 v2, v[216:219] offset:0
    ds_write_b128 v2, v[220:223] offset:16
    ds_write_b128 v2, v[224:227] offset:32
    ds_write_b128 v2, v[228:231] offset:48
    ds_write_b128 v2, v[244:247] offset:64
    ds_write_b128 v2, v[248:251] offset:80
    ds_write_b128 v2, v[252:255] offset:96
    ds_read_b64_tr_b16 v[32:33], v3 offset:64
    ds_read_b64_tr_b16 v[34:35], v3 offset:176
    ds_read_b64_tr_b16 v[36:37], v3 offset:0
    ds_read_b64_tr_b16 v[38:39], v3 offset:112
    ds_read_b64_tr_b16 v[40:41], v3 offset:1856
    ds_read_b64_tr_b16 v[42:43], v3 offset:1968
    ds_read_b64_tr_b16 v[44:45], v3 offset:1792
    ds_read_b64_tr_b16 v[46:47], v3 offset:1904
    ds_read_b64_tr_b16 v[48:49], v3 offset:3648
    ds_read_b64_tr_b16 v[50:51], v3 offset:3760
    ds_read_b64_tr_b16 v[52:53], v3 offset:3584
    ds_read_b64_tr_b16 v[54:55], v3 offset:3696
    ds_read_b64_tr_b16 v[56:57], v3 offset:5440
    ds_read_b64_tr_b16 v[58:59], v3 offset:5552
    ds_read_b64_tr_b16 v[60:61], v3 offset:5376
    ds_read_b64_tr_b16 v[62:63], v3 offset:5488
    s_waitcnt lgkmcnt(12)
    v_mfma_f32_32x32x16_f16 v[64:79], v[32:35], v[36:39], v[64:79]
    s_waitcnt lgkmcnt(8)
    v_mfma_f32_32x32x16_f16 v[64:79], v[40:43], v[44:47], v[64:79]
    s_waitcnt lgkmcnt(4)
    v_mfma_f32_32x32x16_f16 v[64:79], v[48:51], v[52:55], v[64:79]
    s_waitcnt lgkmcnt(0)
    v_mfma_f32_32x32x16_f16 v[64:79], v[56:59], v[60:63], v[64:79]
    v_and_b32 v230, 15, v1
    v_lshrrev_b32 v231, 4, v1
    v_and_b32 v232, 1, v230
    v_lshlrev_b32 v233, 3, v231
    v_sub_u32 v233, v233, v230
    v_sub_u32 v233, v233, v232
    v_add_u32 v233, 1776, v233
    v_lshlrev_b32 v233, 1, v233
    v_mul_u32_u24 v232, 4160, v232
    v_add3_u32 v240, v233, v232, s52
    v_add_u32 v241, -1024, v240
    v_add_u32 v242, -2048, v240
    v_add_u32 v243, -3072, v240
    v_lshlrev_b32 v232, 5, v230
    v_lshl_add_u32 v232, v231, 4, v232
    s_add_u32 s28, s52, 8768
    v_add_u32 v244, s28, v232
    v_and_b32 v232, 1, v1
    v_cmp_eq_u32 vcc, 0, v232
    v_lshlrev_b32 v30, 2, v1
    v_add_u32 v30, s52, v30
    v_mov_b32 v228, 0
    s_mov_b64 exec, 0xffff
    ds_write_b32 v30, v228 offset:4096
    s_mov_b64 exec, -1
    v_mul_f32 v64, s79, v64
    v_mul_f32 v65, s79, v65
    v_mul_f32 v66, s79, v66
    v_mul_f32 v67, s79, v67
    v_mul_f32 v68, s79, v68
    v_mul_f32 v69, s79, v69
    v_mul_f32 v70, s79, v70
    v_mul_f32 v71, s79, v71
    v_mul_f32 v72, s79, v72
    v_mul_f32 v73, s79, v73
    v_mul_f32 v74, s79, v74
    v_mul_f32 v75, s79, v75
    v_readlane_b32 s28, v68, 32
    v_mov_b32_dpp v24, v72 wave_rol:1 row_mask:0xf bank_mask:0xf
    v_mov_b32_dpp v25, v74 wave_rol:1 row_mask:0xf bank_mask:0xf
    v_mov_b32_dpp v26, v75 wave_rol:1 row_mask:0xf bank_mask:0xf
    v_mov_b32 v27, s28
    v_mov_b32_dpp v24, v64 wave_shl:1 row_mask:0xf bank_mask:0xf
    v_mov_b32_dpp v25, v72 wave_shl:1 row_mask:0xf bank_mask:0xf
    v_mov_b32_dpp v26, v74 wave_shl:1 row_mask:0xf bank_mask:0xf
    v_mov_b32_dpp v27, v75 wave_shl:1 row_mask:0xf bank_mask:0xf
    s_mov_b32 exec_lo, 0
    v_mov_b32 v68, v64
    v_mov_b32 v70, v65
    v_mov_b32 v69, v65
    v_mov_b32 v71, v24
    s_mov_b32 exec_lo, -1
    v_cndmask_b32 v28, v26, v74, vcc
    v_cndmask_b32 v29, v27, v75, vcc
    v_cvt_pk_bf16_f32 v32, v24, v71
    v_cvt_pk_bf16_f32 v33, v67, v69
    v_cvt_pk_bf16_f32 v34, v65, v70
    v_cvt_pk_bf16_f32 v35, v66, v68
    ds_write_b128 v5, v[32:35] offset:3072
    v_cvt_pk_bf16_f32 v36, v71, v67
    v_cvt_pk_bf16_f32 v37, v69, v65
    v_cvt_pk_bf16_f32 v38, v70, v66
    v_cvt_pk_bf16_f32 v39, v68, v64
    ds_write_b128 v5, v[36:39] offset:7232
    v_mov_b32 v30, s52
    s_mov_b64 exec, 1
    ds_write_b16_d16_hi v30, v39 offset:4096
    s_mov_b64 exec, -1
    v_cvt_pk_bf16_f32 v40, v25, v25
    v_cvt_pk_bf16_f32 v41, v25, v73
    v_cvt_pk_bf16_f32 v42, v73, v73
    v_cvt_pk_bf16_f32 v43, v72, v72
    ds_write_b128 v5, v[40:43] offset:2048
    v_cvt_pk_bf16_f32 v44, v25, v25
    v_cvt_pk_bf16_f32 v45, v73, v73
    v_cvt_pk_bf16_f32 v46, v73, v72
    v_cvt_pk_bf16_f32 v47, v72, v72
    ds_write_b128 v5, v[44:47] offset:6208
    v_cvt_pk_bf16_f32 v48, v26, v26
    v_cvt_pk_bf16_f32 v49, v26, v26
    v_cvt_pk_bf16_f32 v50, v28, v74
    v_cvt_pk_bf16_f32 v51, v74, v74
    ds_write_b128 v5, v[48:51] offset:1024
    v_cvt_pk_bf16_f32 v52, v26, v26
    v_cvt_pk_bf16_f32 v53, v26, v28
    v_cvt_pk_bf16_f32 v54, v74, v74
    v_cvt_pk_bf16_f32 v55, v74, v74
    ds_write_b128 v5, v[52:55] offset:5184
    v_cvt_pk_bf16_f32 v56, v27, v27
    v_cvt_pk_bf16_f32 v57, v27, v27
    v_cvt_pk_bf16_f32 v58, v29, v75
    v_cvt_pk_bf16_f32 v59, v75, v75
    ds_write_b128 v5, v[56:59] offset:0
    v_cvt_pk_bf16_f32 v60, v27, v27
    v_cvt_pk_bf16_f32 v61, v27, v29
    v_cvt_pk_bf16_f32 v62, v75, v75
    v_cvt_pk_bf16_f32 v63, v75, v75
    ds_write_b128 v5, v[60:63] offset:4160
    s_setprio 0
    s_setprio 2
    v_mov_b32 v31, 1
    s_waitcnt vmcnt(0)
    s_waitcnt vmcnt(0)
    ds_read2_b32 v[64:65], v240 offset0:128 offset1:129
    ds_read2_b32 v[66:67], v240 offset0:130 offset1:131
    ds_read_b128 v[96:99], v244 offset:0
    ds_read2_b32 v[68:69], v240 offset0:0 offset1:1
    ds_read2_b32 v[70:71], v240 offset0:2 offset1:3
    ds_read_b128 v[100:103], v244 offset:512
    ds_read2_b32 v[72:73], v241 offset0:128 offset1:129
    ds_read2_b32 v[74:75], v241 offset0:130 offset1:131
    ds_read_b128 v[104:107], v244 offset:1024
    ds_read2_b32 v[76:77], v241 offset0:0 offset1:1
    ds_read2_b32 v[78:79], v241 offset0:2 offset1:3
    ds_read_b128 v[108:111], v244 offset:1536
    ds_read2_b32 v[80:81], v242 offset0:128 offset1:129
    ds_read2_b32 v[82:83], v242 offset0:130 offset1:131
    ds_read_b128 v[112:115], v244 offset:2048
    ds_read2_b32 v[84:85], v242 offset0:0 offset1:1
    ds_read2_b32 v[86:87], v242 offset0:2 offset1:3
    ds_read_b128 v[116:119], v244 offset:2560
    ds_read2_b32 v[88:89], v243 offset0:128 offset1:129
    ds_read2_b32 v[90:91], v243 offset0:130 offset1:131
    ds_read_b128 v[120:123], v244 offset:3072
    ds_read2_b32 v[92:93], v243 offset0:0 offset1:1
    ds_read2_b32 v[94:95], v243 offset0:2 offset1:3
    ds_read_b128 v[124:127], v244 offset:3584
    v_add_u32 v240, -64, v240
    v_add_u32 v241, -64, v241
    v_add_u32 v242, -64, v242
    v_add_u32 v243, -64, v243
    v_add_u32 v244, -64, v244
    v_mov_b32 v32, 0
    v_mov_b32 v33, 0
    v_mov_b32 v34, 0
    v_mov_b32 v35, 0
    v_mov_b32 v36, 0
    v_mov_b32 v37, 0
    v_mov_b32 v38, 0
    v_mov_b32 v39, 0
    v_mov_b32 v40, 0
    v_mov_b32 v41, 0
    v_mov_b32 v42, 0
    v_mov_b32 v43, 0
    v_mov_b32 v44, 0
    v_mov_b32 v45, 0
    v_mov_b32 v46, 0
    v_mov_b32 v47, 0
    v_mov_b32 v48, 0
    v_mov_b32 v49, 0
    v_mov_b32 v50, 0
    v_mov_b32 v51, 0
    v_mov_b32 v52, 0
    v_mov_b32 v53, 0
    v_mov_b32 v54, 0
    v_mov_b32 v55, 0
    v_mov_b32 v56, 0
    v_mov_b32 v57, 0
    v_mov_b32 v58, 0
    v_mov_b32 v59, 0
    v_mov_b32 v60, 0
    v_mov_b32 v61, 0
    v_mov_b32 v62, 0
    v_mov_b32 v63, 0
    s_mov_b32 s48, 0
    s_mov_b32 s30, 0
Lp_71:
    ds_read_b32 v30, v7 offset:64
    s_waitcnt lgkmcnt(0)
    v_readfirstlane_b32 s31, v30
    s_cmp_ge_u32 s31, 4
    s_cbranch_scc1 Lpd_72
    s_sleep 2
    s_add_u32 s30, s30, 1
    s_cmp_lt_u32 s30, 262144
    s_cbranch_scc1 Lp_71
Lpd_72:
Lconv:
    s_waitcnt lgkmcnt(0)
    v_mfma_f32_16x16x32_bf16 v[32:35], v[64:67], v[96:99], v[32:35]
    ds_read2_b32 v[128:129], v240 offset0:128 offset1:129
    v_mfma_f32_16x16x32_bf16 v[36:39], v[64:67], v[100:103], v[36:39]
    ds_read2_b32 v[130:131], v240 offset0:130 offset1:131
    v_mfma_f32_16x16x32_bf16 v[40:43], v[64:67], v[104:107], v[40:43]
    ds_read_b128 v[160:163], v244 offset:0
    v_mfma_f32_16x16x32_bf16 v[44:47], v[64:67], v[108:111], v[44:47]
    ds_read2_b32 v[132:133], v240 offset0:0 offset1:1
    v_mfma_f32_16x16x32_bf16 v[48:51], v[64:67], v[112:115], v[48:51]
    ds_read2_b32 v[134:135], v240 offset0:2 offset1:3
    v_mfma_f32_16x16x32_bf16 v[52:55], v[64:67], v[116:119], v[52:55]
    ds_read_b128 v[164:167], v244 offset:512
    v_mfma_f32_16x16x32_bf16 v[56:59], v[64:67], v[120:123], v[56:59]
    ds_read2_b32 v[136:137], v241 offset0:128 offset1:129
    v_mfma_f32_16x16x32_bf16 v[60:63], v[64:67], v[124:127], v[60:63]
    ds_read2_b32 v[138:139], v241 offset0:130 offset1:131
    v_mfma_f32_16x16x32_bf16 v[36:39], v[68:71], v[96:99], v[36:39]
    ds_read_b128 v[168:171], v244 offset:1024
    v_mfma_f32_16x16x32_bf16 v[40:43], v[68:71], v[100:103], v[40:43]
    ds_read2_b32 v[140:141], v241 offset0:0 offset1:1
    v_mfma_f32_16x16x32_bf16 v[44:47], v[68:71], v[104:107], v[44:47]
    ds_read2_b32 v[142:143], v241 offset0:2 offset1:3
    v_mfma_f32_16x16x32_bf16 v[48:51], v[68:71], v[108:111], v[48:51]
    ds_read_b128 v[172:175], v244 offset:1536
    v_mfma_f32_16x16x32_bf16 v[52:55], v[68:71], v[112:115], v[52:55]
    ds_read2_b32 v[144:145], v242 offset0:128 offset1:129
    v_mfma_f32_16x16x32_bf16 v[56:59], v[68:71], v[116:119], v[56:59]
    ds_read2_b32 v[146:147], v242 offset0:130 offset1:131
    v_mfma_f32_16x16x32_bf16 v[60:63], v[68:71], v[120:123], v[60:63]
    ds_read_b128 v[176:179], v244 offset:2048
    v_mfma_f32_16x16x32_bf16 v[40:43], v[72:75], v[96:99], v[40:43]
    ds_read2_b32 v[148:149], v242 offset0:0 offset1:1
    v_mfma_f32_16x16x32_bf16 v[44:47], v[72:75], v[100:103], v[44:47]
    ds_read2_b32 v[150:151], v242 offset0:2 offset1:3
    v_mfma_f32_16x16x32_bf16 v[48:51], v[72:75], v[104:107], v[48:51]
    ds_read_b128 v[180:183], v244 offset:2560
    v_mfma_f32_16x16x32_bf16 v[52:55], v[72:75], v[108:111], v[52:55]
    ds_read2_b32 v[152:153], v243 offset0:128 offset1:129
    v_mfma_f32_16x16x32_bf16 v[56:59], v[72:75], v[112:115], v[56:59]
    ds_read2_b32 v[154:155], v243 offset0:130 offset1:131
    v_mfma_f32_16x16x32_bf16 v[60:63], v[72:75], v[116:119], v[60:63]
    ds_read_b128 v[184:187], v244 offset:3072
    v_mfma_f32_16x16x32_bf16 v[44:47], v[76:79], v[96:99], v[44:47]
    ds_read2_b32 v[156:157], v243 offset0:0 offset1:1
    v_mfma_f32_16x16x32_bf16 v[48:51], v[76:79], v[100:103], v[48:51]
    ds_read2_b32 v[158:159], v243 offset0:2 offset1:3
    v_mfma_f32_16x16x32_bf16 v[52:55], v[76:79], v[104:107], v[52:55]
    ds_read_b128 v[188:191], v244 offset:3584
    v_mfma_f32_16x16x32_bf16 v[56:59], v[76:79], v[108:111], v[56:59]
    v_mfma_f32_16x16x32_bf16 v[60:63], v[76:79], v[112:115], v[60:63]
    v_add_u32 v240, -64, v240
    v_add_u32 v241, -64, v241
    v_add_u32 v242, -64, v242
    v_add_u32 v243, -64, v243
    v_add_u32 v244, -64, v244
    v_mfma_f32_16x16x32_bf16 v[48:51], v[80:83], v[96:99], v[48:51]
    v_mfma_f32_16x16x32_bf16 v[52:55], v[80:83], v[100:103], v[52:55]
    v_mfma_f32_16x16x32_bf16 v[56:59], v[80:83], v[104:107], v[56:59]
    v_mfma_f32_16x16x32_bf16 v[60:63], v[80:83], v[108:111], v[60:63]
    v_mfma_f32_16x16x32_bf16 v[52:55], v[84:87], v[96:99], v[52:55]
    v_mfma_f32_16x16x32_bf16 v[56:59], v[84:87], v[100:103], v[56:59]
    v_mfma_f32_16x16x32_bf16 v[60:63], v[84:87], v[104:107], v[60:63]
    v_mfma_f32_16x16x32_bf16 v[56:59], v[88:91], v[96:99], v[56:59]
    v_mfma_f32_16x16x32_bf16 v[60:63], v[88:91], v[100:103], v[60:63]
    v_mfma_f32_16x16x32_bf16 v[60:63], v[92:95], v[96:99], v[60:63]
    s_waitcnt lgkmcnt(0)
    s_cmp_eq_u32 s48, 3
    s_cbranch_scc1 Lclast
    v_mfma_f32_16x16x32_bf16 v[32:35], v[128:131], v[160:163], v[32:35]
    ds_read2_b32 v[64:65], v240 offset0:128 offset1:129
    v_mfma_f32_16x16x32_bf16 v[36:39], v[128:131], v[164:167], v[36:39]
    ds_read2_b32 v[66:67], v240 offset0:130 offset1:131
    v_mfma_f32_16x16x32_bf16 v[40:43], v[128:131], v[168:171], v[40:43]
    ds_read_b128 v[96:99], v244 offset:0
    v_mfma_f32_16x16x32_bf16 v[44:47], v[128:131], v[172:175], v[44:47]
    ds_read2_b32 v[68:69], v240 offset0:0 offset1:1
    v_mfma_f32_16x16x32_bf16 v[48:51], v[128:131], v[176:179], v[48:51]
    ds_read2_b32 v[70:71], v240 offset0:2 offset1:3
    v_mfma_f32_16x16x32_bf16 v[52:55], v[128:131], v[180:183], v[52:55]
    ds_read_b128 v[100:103], v244 offset:512
    v_mfma_f32_16x16x32_bf16 v[56:59], v[128:131], v[184:187], v[56:59]
    ds_read2_b32 v[72:73], v241 offset0:128 offset1:129
    v_mfma_f32_16x16x32_bf16 v[60:63], v[128:131], v[188:191], v[60:63]
    ds_read2_b32 v[74:75], v241 offset0:130 offset1:131
    v_mfma_f32_16x16x32_bf16 v[36:39], v[132:135], v[160:163], v[36:39]
    ds_read_b128 v[104:107], v244 offset:1024
    v_mfma_f32_16x16x32_bf16 v[40:43], v[132:135], v[164:167], v[40:43]
    ds_read2_b32 v[76:77], v241 offset0:0 offset1:1
    v_mfma_f32_16x16x32_bf16 v[44:47], v[132:135], v[168:171], v[44:47]
    ds_read2_b32 v[78:79], v241 offset0:2 offset1:3
    v_mfma_f32_16x16x32_bf16 v[48:51], v[132:135], v[172:175], v[48:51]
    ds_read_b128 v[108:111], v244 offset:1536
    v_mfma_f32_16x16x32_bf16 v[52:55], v[132:135], v[176:179], v[52:55]
    ds_read2_b32 v[80:81], v242 offset0:128 offset1:129
    v_mfma_f32_16x16x32_bf16 v[56:59], v[132:135], v[180:183], v[56:59]
    ds_read2_b32 v[82:83], v242 offset0:130 offset1:131
    v_mfma_f32_16x16x32_bf16 v[60:63], v[132:135], v[184:187], v[60:63]
    ds_read_b128 v[112:115], v244 offset:2048
    v_mfma_f32_16x16x32_bf16 v[40:43], v[136:139], v[160:163], v[40:43]
    ds_read2_b32 v[84:85], v242 offset0:0 offset1:1
    v_mfma_f32_16x16x32_bf16 v[44:47], v[136:139], v[164:167], v[44:47]
    ds_read2_b32 v[86:87], v242 offset0:2 offset1:3
    v_mfma_f32_16x16x32_bf16 v[48:51], v[136:139], v[168:171], v[48:51]
    ds_read_b128 v[116:119], v244 offset:2560
    v_mfma_f32_16x16x32_bf16 v[52:55], v[136:139], v[172:175], v[52:55]
    ds_read2_b32 v[88:89], v243 offset0:128 offset1:129
    v_mfma_f32_16x16x32_bf16 v[56:59], v[136:139], v[176:179], v[56:59]
    ds_read2_b32 v[90:91], v243 offset0:130 offset1:131
    v_mfma_f32_16x16x32_bf16 v[60:63], v[136:139], v[180:183], v[60:63]
    ds_read_b128 v[120:123], v244 offset:3072
    v_mfma_f32_16x16x32_bf16 v[44:47], v[140:143], v[160:163], v[44:47]
    ds_read2_b32 v[92:93], v243 offset0:0 offset1:1
    v_mfma_f32_16x16x32_bf16 v[48:51], v[140:143], v[164:167], v[48:51]
    ds_read2_b32 v[94:95], v243 offset0:2 offset1:3
    v_mfma_f32_16x16x32_bf16 v[52:55], v[140:143], v[168:171], v[52:55]
    ds_read_b128 v[124:127], v244 offset:3584
    v_mfma_f32_16x16x32_bf16 v[56:59], v[140:143], v[172:175], v[56:59]
    v_mfma_f32_16x16x32_bf16 v[60:63], v[140:143], v[176:179], v[60:63]
    v_add_u32 v240, -64, v240
    v_add_u32 v241, -64, v241
    v_add_u32 v242, -64, v242
    v_add_u32 v243, -64, v243
    v_add_u32 v244, -64, v244
    v_mfma_f32_16x16x32_bf16 v[48:51], v[144:147], v[160:163], v[48:51]
    v_mfma_f32_16x16x32_bf16 v[52:55], v[144:147], v[164:167], v[52:55]
    v_mfma_f32_16x16x32_bf16 v[56:59], v[144:147], v[168:171], v[56:59]
    v_mfma_f32_16x16x32_bf16 v[60:63], v[144:147], v[172:175], v[60:63]
    v_mfma_f32_16x16x32_bf16 v[52:55], v[148:151], v[160:163], v[52:55]
    v_mfma_f32_16x16x32_bf16 v[56:59], v[148:151], v[164:167], v[56:59]
    v_mfma_f32_16x16x32_bf16 v[60:63], v[148:151], v[168:171], v[60:63]
    v_mfma_f32_16x16x32_bf16 v[56:59], v[152:155], v[160:163], v[56:59]
    v_mfma_f32_16x16x32_bf16 v[60:63], v[152:155], v[164:167], v[60:63]
    v_mfma_f32_16x16x32_bf16 v[60:63], v[156:159], v[160:163], v[60:63]
    s_add_u32 s48, s48, 1
    s_branch Lconv
Lclast:
    s_mov_b64 exec, 1
    ds_add_u32 v7, v31 offset:48
    s_mov_b64 exec, -1
    v_mfma_f32_16x16x32_bf16 v[60:63], v[128:131], v[188:191], v[60:63]
    v_mfma_f32_16x16x32_bf16 v[56:59], v[128:131], v[184:187], v[56:59]
    v_mfma_f32_16x16x32_bf16 v[60:63], v[132:135], v[184:187], v[60:63]
    v_mfma_f32_16x16x32_bf16 v[56:59], v[132:135], v[180:183], v[56:59]
    v_mfma_f32_16x16x32_bf16 v[60:63], v[136:139], v[180:183], v[60:63]
    v_mfma_f32_16x16x32_bf16 v[56:59], v[136:139], v[176:179], v[56:59]
    v_mfma_f32_16x16x32_bf16 v[60:63], v[140:143], v[176:179], v[60:63]
    v_mfma_f32_16x16x32_bf16 v[56:59], v[140:143], v[172:175], v[56:59]
    v_mfma_f32_16x16x32_bf16 v[60:63], v[144:147], v[172:175], v[60:63]
    v_mfma_f32_16x16x32_bf16 v[56:59], v[144:147], v[168:171], v[56:59]
    v_mfma_f32_16x16x32_bf16 v[60:63], v[148:151], v[168:171], v[60:63]
    v_mfma_f32_16x16x32_bf16 v[56:59], v[148:151], v[164:167], v[56:59]
    v_mfma_f32_16x16x32_bf16 v[60:63], v[152:155], v[164:167], v[60:63]
    v_mfma_f32_16x16x32_bf16 v[56:59], v[152:155], v[160:163], v[56:59]
    v_mfma_f32_16x16x32_bf16 v[60:63], v[156:159], v[160:163], v[60:63]
    v_mfma_f32_16x16x32_bf16 v[52:55], v[128:131], v[180:183], v[52:55]
    v_mfma_f32_16x16x32_bf16 v[48:51], v[128:131], v[176:179], v[48:51]
    s_nop 4
    v_cvt_pk_bf16_f32 v76, v56, v57
    v_cvt_pk_bf16_f32 v77, v58, v59
    v_mfma_f32_16x16x32_bf16 v[52:55], v[132:135], v[176:179], v[52:55]
    v_cvt_pk_bf16_f32 v78, v60, v61
    v_cvt_pk_bf16_f32 v79, v62, v63
    v_mfma_f32_16x16x32_bf16 v[48:51], v[132:135], v[172:175], v[48:51]
    v_permlane16_swap_b32 v76, v78
    v_permlane16_swap_b32 v77, v79
    v_mfma_f32_16x16x32_bf16 v[52:55], v[136:139], v[172:175], v[52:55]
    buffer_store_dwordx4 v[76:79], v6, s[8:11], s78 offen offset:3072 sc1
    v_mfma_f32_16x16x32_bf16 v[48:51], v[136:139], v[168:171], v[48:51]
    v_mfma_f32_16x16x32_bf16 v[52:55], v[140:143], v[168:171], v[52:55]
    v_mfma_f32_16x16x32_bf16 v[48:51], v[140:143], v[164:167], v[48:51]
    v_mfma_f32_16x16x32_bf16 v[52:55], v[144:147], v[164:167], v[52:55]
    v_mfma_f32_16x16x32_bf16 v[48:51], v[144:147], v[160:163], v[48:51]
    v_mfma_f32_16x16x32_bf16 v[52:55], v[148:151], v[160:163], v[52:55]
    v_mfma_f32_16x16x32_bf16 v[44:47], v[128:131], v[172:175], v[44:47]
    v_mfma_f32_16x16x32_bf16 v[40:43], v[128:131], v[168:171], v[40:43]
    s_nop 4
    v_cvt_pk_bf16_f32 v72, v48, v49
    v_cvt_pk_bf16_f32 v73, v50, v51
    v_mfma_f32_16x16x32_bf16 v[44:47], v[132:135], v[168:171], v[44:47]
    v_cvt_pk_bf16_f32 v74, v52, v53
    v_cvt_pk_bf16_f32 v75, v54, v55
    v_mfma_f32_16x16x32_bf16 v[40:43], v[132:135], v[164:167], v[40:43]
    v_permlane16_swap_b32 v72, v74
    v_permlane16_swap_b32 v73, v75
    v_mfma_f32_16x16x32_bf16 v[44:47], v[136:139], v[164:167], v[44:47]
    buffer_store_dwordx4 v[72:75], v6, s[8:11], s78 offen offset:2048 sc1
    v_mfma_f32_16x16x32_bf16 v[40:43], v[136:139], v[160:163], v[40:43]
    v_mfma_f32_16x16x32_bf16 v[44:47], v[140:143], v[160:163], v[44:47]
    v_mfma_f32_16x16x32_bf16 v[36:39], v[128:131], v[164:167], v[36:39]
    v_mfma_f32_16x16x32_bf16 v[32:35], v[128:131], v[160:163], v[32:35]
    s_nop 4
    v_cvt_pk_bf16_f32 v68, v40, v41
    v_cvt_pk_bf16_f32 v69, v42, v43
    v_cvt_pk_bf16_f32 v70, v44, v45
    v_cvt_pk_bf16_f32 v71, v46, v47
    v_mfma_f32_16x16x32_bf16 v[36:39], v[132:135], v[160:163], v[36:39]
    v_permlane16_swap_b32 v68, v70
    v_permlane16_swap_b32 v69, v71
    buffer_store_dwordx4 v[68:71], v6, s[8:11], s78 offen offset:1024 sc1
    v_cvt_pk_bf16_f32 v64, v32, v33
    v_cvt_pk_bf16_f32 v65, v34, v35
    s_nop 2
    v_cvt_pk_bf16_f32 v66, v36, v37
    v_cvt_pk_bf16_f32 v67, v38, v39
    s_nop 0
    v_permlane16_swap_b32 v64, v66
    v_permlane16_swap_b32 v65, v67
    buffer_store_dwordx4 v[64:67], v6, s[8:11], s78 offen offset:0 sc1
    s_lshr_b32 s29, s99, 4
    s_mul_i32 s29, s29, 3776
    s_lshl_b32 s28, s53, 2
    s_add_u32 s28, s28, s29
    s_add_u32 s28, s28, 15007744
    s_waitcnt vmcnt(0)
    v_mov_b32 v2, s12
    v_lshlrev_b32 v3, 9, v1
    s_mov_b64 exec, 255
    buffer_store_dword v2, v3, s[8:11], s28 offen sc1
    s_mov_b64 exec, -1
    s_endpgm
.p2align 7
Lwd:
    s_lshr_b32 s30, s28, 2
    s_lshl_b32 s30, s30, 3
    s_lshr_b32 s31, s29, 2
    s_add_u32 s101, s30, s31
    s_and_b32 s30, s28, 3
    s_and_b32 s31, s29, 3
    s_lshl_b32 s14, s30, 2
    s_add_u32 s14, s14, s31
    s_mul_i32 s31, s31, 5
    s_add_u32 s31, s31, 1
    s_lshr_b32 s31, s31, 1
    s_lshr_b32 s30, s29, 2
    s_add_u32 s31, s31, s30
    s_lshr_b32 s30, s29, 4
    s_add_u32 s17, s31, s30
    s_cmp_ge_u32 s17, 10
    s_cselect_b32 s30, 10, 0
    s_sub_u32 s17, s17, s30
    s_and_b32 s28, s2, 7
    s_lshr_b32 s29, s2, 3
    s_lshr_b32 s30, s29, 3
    s_lshl_b32 s15, s28, 2
    s_add_u32 s15, s15, s30
    s_and_b32 s16, s29, 7
    s_mul_i32 s30, s30, 3
    s_mul_i32 s31, s16, 3
    s_lshr_b32 s31, s31, 1
    s_add_u32 s98, s30, s31
    s_cmp_ge_u32 s98, 12
    s_cselect_b32 s30, 12, 0
    s_sub_u32 s98, s98, s30
    s_lshr_b32 s29, s29, 1
    s_lshl_b32 s29, s29, 3
    s_add_u32 s99, s29, s28
    s_lshr_b32 s28, s15, 1
    s_lshl_b32 s28, s28, 7
    s_and_b32 s29, s15, 1
    s_lshl_b32 s29, s29, 3
    s_add_u32 s100, s28, s29
    s_mul_i32 s52, s54, 13568
    s_add_u32 s52, s52, 122976
    s_setprio 3
    s_load_dwordx2 s[32:33], s[0:1], 80
    s_lshr_b32 s41, s99, 4
    s_and_b32 s42, s99, 15
    s_mul_i32 s43, s42, 122880
    s_mul_i32 s28, s41, 160
    s_add_u32 s43, s43, s28
    v_add_u32 v2, 0, v1
    v_mul_u32_u24 v3, 0x199a, v2
    v_lshrrev_b32 v3, 16, v3
    v_mul_u32_u24 v4, 10, v3
    v_sub_u32 v4, v2, v4
    v_mul_u32_u24 v3, 1280, v3
    v_lshl_add_u32 v10, v4, 4, v3
    v_add_u32 v2, 64, v1
    v_mul_u32_u24 v3, 0x199a, v2
    v_lshrrev_b32 v3, 16, v3
    v_mul_u32_u24 v4, 10, v3
    v_sub_u32 v4, v2, v4
    v_mul_u32_u24 v3, 1280, v3
    v_lshl_add_u32 v11, v4, 4, v3
    v_add_u32 v2, 128, v1
    v_mul_u32_u24 v3, 0x199a, v2
    v_lshrrev_b32 v3, 16, v3
    v_mul_u32_u24 v4, 10, v3
    v_sub_u32 v4, v2, v4
    v_mul_u32_u24 v3, 1280, v3
    v_lshl_add_u32 v12, v4, 4, v3
    v_add_u32 v2, 192, v1
    v_mul_u32_u24 v3, 0x199a, v2
    v_lshrrev_b32 v3, 16, v3
    v_mul_u32_u24 v4, 10, v3
    v_sub_u32 v4, v2, v4
    v_mul_u32_u24 v3, 1280, v3
    v_lshl_add_u32 v13, v4, 4, v3
    v_add_u32 v2, 256, v1
    v_mul_u32_u24 v3, 0x199a, v2
    v_lshrrev_b32 v3, 16, v3
    v_mul_u32_u24 v4, 10, v3
    v_sub_u32 v4, v2, v4
    v_mul_u32_u24 v3, 1280, v3
    v_lshl_add_u32 v14, v4, 4, v3
    s_waitcnt lgkmcnt(0)
    s_mov_b32 s36, s32
    s_mov_b32 s37, s33
    s_mov_b32 s38, 1966080
    s_mov_b32 s39, 0x00020000
    s_mov_b32 s8, s22
    s_mov_b32 s9, s23
    s_mov_b32 s10, 33554432
    s_mov_b32 s11, 0x00020000
    s_add_u32 s28, s22, 14680064
    s_addc_u32 s29, s23, 0
    s_load_dword s12, s[28:29], 0
    v_lshrrev_b32 v2, 5, v1
    v_lshlrev_b32 v2, 4, v2
    v_bfe_u32 v3, v1, 4, 1
    v_lshl_add_u32 v2, v3, 2, v2
    v_bfe_u32 v3, v1, 2, 2
    v_add_u32 v2, v2, v3
    v_mul_u32_u24 v2, 160, v2
    v_add_u32 v2, s52, v2
    v_and_b32 v3, 3, v1
    v_lshl_add_u32 v5, v3, 4, v2
    v_lshl_add_u32 v6, v3, 3, v2
    v_lshlrev_b32 v7, 4, v1
    s_mul_i32 s45, s41, 48
    s_mul_i32 s28, s42, 3
    s_add_u32 s45, s45, s28
    s_mul_i32 s45, s45, 5120
    s_add_u32 s45, s45, 6291456
    v_mov_b32 v21, 163680
    v_add_u32 v23, s52, v7
    s_lshr_b32 s40, s14, 2
    v_lshrrev_b32 v32, 5, v1
    v_and_b32 v33, 1, v1
    v_lshl_add_u32 v32, v32, 1, v33
    v_lshlrev_b32 v32, 12, v32
    v_bfe_u32 v33, v1, 2, 2
    v_lshl_add_u32 v32, v33, 7, v32
    v_bfe_u32 v34, v1, 1, 1
    v_lshl_add_u32 v32, v34, 3, v32
    v_bfe_u32 v34, v1, 4, 1
    v_bfe_u32 v33, v1, 3, 1
    v_xor_b32 v33, v33, v34
    s_lshl_b32 s28, s40, 1
    v_xor_b32 v33, s28, v33
    v_lshl_add_u32 v24, v33, 4, v32
    v_xor_b32 v25, 32, v24
    v_add_u32 v25, 512, v25
    v_xor_b32 v26, 64, v24
    v_xor_b32 v27, 64, v25
    v_bfe_u32 v32, v1, 3, 2
    v_lshlrev_b32 v32, 14, v32
    v_and_b32 v33, 7, v1
    v_lshl_add_u32 v32, v33, 4, v32
    v_lshrrev_b32 v33, 5, v1
    v_lshl_add_u32 v20, v33, 7, v32
    s_mov_b32 s34, s17
    s_lshl_b32 s33, s40, 16
    s_lshl_b32 s28, s101, 8
    s_add_u32 s33, s33, s28
    s_add_u32 s33, s33, 8388608
    s_waitcnt lgkmcnt(0)
    s_mul_i32 s12, s12, 0x9E3779B1
    s_add_u32 s12, s12, 0x7F4A7C15
    s_mov_b32 s13, s12
    s_barrier
    ds_read_b64_tr_b16 v[32:33], v24 offset:40992
    ds_read_b64_tr_b16 v[34:35], v25 offset:40992
    ds_read_b64_tr_b16 v[36:37], v24 offset:42016
    ds_read_b64_tr_b16 v[38:39], v25 offset:42016
    ds_read_b64_tr_b16 v[40:41], v26 offset:43040
    ds_read_b64_tr_b16 v[42:43], v27 offset:43040
    ds_read_b64_tr_b16 v[44:45], v26 offset:44064
    ds_read_b64_tr_b16 v[46:47], v27 offset:44064
    s_waitcnt lgkmcnt(0)
    s_mov_b32 vcc_lo, 0x55555555
    s_mov_b32 vcc_hi, 0x55555555
    v_cndmask_b32_dpp v48, v36, v32, vcc quad_perm:[1,0,3,2] row_mask:0xf bank_mask:0xf
    v_cndmask_b32_dpp v49, v37, v33, vcc quad_perm:[1,0,3,2] row_mask:0xf bank_mask:0xf
    v_cndmask_b32_dpp v50, v38, v34, vcc quad_perm:[1,0,3,2] row_mask:0xf bank_mask:0xf
    v_cndmask_b32_dpp v51, v39, v35, vcc quad_perm:[1,0,3,2] row_mask:0xf bank_mask:0xf
    v_cndmask_b32_dpp v56, v44, v40, vcc quad_perm:[1,0,3,2] row_mask:0xf bank_mask:0xf
    v_cndmask_b32_dpp v57, v45, v41, vcc quad_perm:[1,0,3,2] row_mask:0xf bank_mask:0xf
    v_cndmask_b32_dpp v58, v46, v42, vcc quad_perm:[1,0,3,2] row_mask:0xf bank_mask:0xf
    v_cndmask_b32_dpp v59, v47, v43, vcc quad_perm:[1,0,3,2] row_mask:0xf bank_mask:0xf
    s_mov_b32 vcc_lo, 0xaaaaaaaa
    s_mov_b32 vcc_hi, 0xaaaaaaaa
    v_cndmask_b32_dpp v52, v32, v36, vcc quad_perm:[1,0,3,2] row_mask:0xf bank_mask:0xf
    v_cndmask_b32_dpp v53, v33, v37, vcc quad_perm:[1,0,3,2] row_mask:0xf bank_mask:0xf
    v_cndmask_b32_dpp v54, v34, v38, vcc quad_perm:[1,0,3,2] row_mask:0xf bank_mask:0xf
    v_cndmask_b32_dpp v55, v35, v39, vcc quad_perm:[1,0,3,2] row_mask:0xf bank_mask:0xf
    v_cndmask_b32_dpp v60, v40, v44, vcc quad_perm:[1,0,3,2] row_mask:0xf bank_mask:0xf
    v_cndmask_b32_dpp v61, v41, v45, vcc quad_perm:[1,0,3,2] row_mask:0xf bank_mask:0xf
    v_cndmask_b32_dpp v62, v42, v46, vcc quad_perm:[1,0,3,2] row_mask:0xf bank_mask:0xf
    v_cndmask_b32_dpp v63, v43, v47, vcc quad_perm:[1,0,3,2] row_mask:0xf bank_mask:0xf
    s_mov_b32 vcc_lo, 0x33333333
    s_mov_b32 vcc_hi, 0x33333333
    v_cndmask_b32_dpp v32, v56, v48, vcc quad_perm:[2,3,0,1] row_mask:0xf bank_mask:0xf
    v_cndmask_b32_dpp v33, v57, v49, vcc quad_perm:[2,3,0,1] row_mask:0xf bank_mask:0xf
    v_cndmask_b32_dpp v34, v58, v50, vcc quad_perm:[2,3,0,1] row_mask:0xf bank_mask:0xf
    v_cndmask_b32_dpp v35, v59, v51, vcc quad_perm:[2,3,0,1] row_mask:0xf bank_mask:0xf
    v_cndmask_b32_dpp v36, v60, v52, vcc quad_perm:[2,3,0,1] row_mask:0xf bank_mask:0xf
    v_cndmask_b32_dpp v37, v61, v53, vcc quad_perm:[2,3,0,1] row_mask:0xf bank_mask:0xf
    v_cndmask_b32_dpp v38, v62, v54, vcc quad_perm:[2,3,0,1] row_mask:0xf bank_mask:0xf
    v_cndmask_b32_dpp v39, v63, v55, vcc quad_perm:[2,3,0,1] row_mask:0xf bank_mask:0xf
    s_mov_b32 vcc_lo, 0xcccccccc
    s_mov_b32 vcc_hi, 0xcccccccc
    v_cndmask_b32_dpp v40, v48, v56, vcc quad_perm:[2,3,0,1] row_mask:0xf bank_mask:0xf
    v_cndmask_b32_dpp v41, v49, v57, vcc quad_perm:[2,3,0,1] row_mask:0xf bank_mask:0xf
    v_cndmask_b32_dpp v42, v50, v58, vcc quad_perm:[2,3,0,1] row_mask:0xf bank_mask:0xf
    v_cndmask_b32_dpp v43, v51, v59, vcc quad_perm:[2,3,0,1] row_mask:0xf bank_mask:0xf
    v_cndmask_b32_dpp v44, v52, v60, vcc quad_perm:[2,3,0,1] row_mask:0xf bank_mask:0xf
    v_cndmask_b32_dpp v45, v53, v61, vcc quad_perm:[2,3,0,1] row_mask:0xf bank_mask:0xf
    v_cndmask_b32_dpp v46, v54, v62, vcc quad_perm:[2,3,0,1] row_mask:0xf bank_mask:0xf
    v_cndmask_b32_dpp v47, v55, v63, vcc quad_perm:[2,3,0,1] row_mask:0xf bank_mask:0xf
    s_lshl_b32 s51, s34, 18
    s_add_u32 s51, s51, s33
    s_add_u32 s34, s34, 1
    s_cmp_eq_u32 s34, 10
    s_cselect_b32 s34, 0, s34
    s_add_u32 s35, s51, 0
    buffer_store_dwordx4 v[32:35], v20, s[8:11], s35 offen sc1
    s_add_u32 s35, s51, 4096
    buffer_store_dwordx4 v[36:39], v20, s[8:11], s35 offen sc1
    s_add_u32 s35, s51, 8192
    buffer_store_dwordx4 v[40:43], v20, s[8:11], s35 offen sc1
    s_add_u32 s35, s51, 12288
    buffer_store_dwordx4 v[44:47], v20, s[8:11], s35 offen sc1
    s_barrier
    v_add_u32 v28, 81984, v24
    v_add_u32 v29, 81984, v25
    v_add_u32 v30, 81984, v26
    v_add_u32 v31, 81984, v27
    ds_read_b64_tr_b16 v[32:33], v28 offset:0
    ds_read_b64_tr_b16 v[34:35], v29 offset:0
    ds_read_b64_tr_b16 v[36:37], v28 offset:1024
    ds_read_b64_tr_b16 v[38:39], v29 offset:1024
    ds_read_b64_tr_b16 v[40:41], v30 offset:2048
    ds_read_b64_tr_b16 v[42:43], v31 offset:2048
    ds_read_b64_tr_b16 v[44:45], v30 offset:3072
    ds_read_b64_tr_b16 v[46:47], v31 offset:3072
    s_waitcnt lgkmcnt(0)
    s_mov_b32 vcc_lo, 0x55555555
    s_mov_b32 vcc_hi, 0x55555555
    v_cndmask_b32_dpp v48, v36, v32, vcc quad_perm:[1,0,3,2] row_mask:0xf bank_mask:0xf
    v_cndmask_b32_dpp v49, v37, v33, vcc quad_perm:[1,0,3,2] row_mask:0xf bank_mask:0xf
    v_cndmask_b32_dpp v50, v38, v34, vcc quad_perm:[1,0,3,2] row_mask:0xf bank_mask:0xf
    v_cndmask_b32_dpp v51, v39, v35, vcc quad_perm:[1,0,3,2] row_mask:0xf bank_mask:0xf
    v_cndmask_b32_dpp v56, v44, v40, vcc quad_perm:[1,0,3,2] row_mask:0xf bank_mask:0xf
    v_cndmask_b32_dpp v57, v45, v41, vcc quad_perm:[1,0,3,2] row_mask:0xf bank_mask:0xf
    v_cndmask_b32_dpp v58, v46, v42, vcc quad_perm:[1,0,3,2] row_mask:0xf bank_mask:0xf
    v_cndmask_b32_dpp v59, v47, v43, vcc quad_perm:[1,0,3,2] row_mask:0xf bank_mask:0xf
    s_mov_b32 vcc_lo, 0xaaaaaaaa
    s_mov_b32 vcc_hi, 0xaaaaaaaa
    v_cndmask_b32_dpp v52, v32, v36, vcc quad_perm:[1,0,3,2] row_mask:0xf bank_mask:0xf
    v_cndmask_b32_dpp v53, v33, v37, vcc quad_perm:[1,0,3,2] row_mask:0xf bank_mask:0xf
    v_cndmask_b32_dpp v54, v34, v38, vcc quad_perm:[1,0,3,2] row_mask:0xf bank_mask:0xf
    v_cndmask_b32_dpp v55, v35, v39, vcc quad_perm:[1,0,3,2] row_mask:0xf bank_mask:0xf
    v_cndmask_b32_dpp v60, v40, v44, vcc quad_perm:[1,0,3,2] row_mask:0xf bank_mask:0xf
    v_cndmask_b32_dpp v61, v41, v45, vcc quad_perm:[1,0,3,2] row_mask:0xf bank_mask:0xf
    v_cndmask_b32_dpp v62, v42, v46, vcc quad_perm:[1,0,3,2] row_mask:0xf bank_mask:0xf
    v_cndmask_b32_dpp v63, v43, v47, vcc quad_perm:[1,0,3,2] row_mask:0xf bank_mask:0xf
    s_mov_b32 vcc_lo, 0x33333333
    s_mov_b32 vcc_hi, 0x33333333
    v_cndmask_b32_dpp v32, v56, v48, vcc quad_perm:[2,3,0,1] row_mask:0xf bank_mask:0xf
    v_cndmask_b32_dpp v33, v57, v49, vcc quad_perm:[2,3,0,1] row_mask:0xf bank_mask:0xf
    v_cndmask_b32_dpp v34, v58, v50, vcc quad_perm:[2,3,0,1] row_mask:0xf bank_mask:0xf
    v_cndmask_b32_dpp v35, v59, v51, vcc quad_perm:[2,3,0,1] row_mask:0xf bank_mask:0xf
    v_cndmask_b32_dpp v36, v60, v52, vcc quad_perm:[2,3,0,1] row_mask:0xf bank_mask:0xf
    v_cndmask_b32_dpp v37, v61, v53, vcc quad_perm:[2,3,0,1] row_mask:0xf bank_mask:0xf
    v_cndmask_b32_dpp v38, v62, v54, vcc quad_perm:[2,3,0,1] row_mask:0xf bank_mask:0xf
    v_cndmask_b32_dpp v39, v63, v55, vcc quad_perm:[2,3,0,1] row_mask:0xf bank_mask:0xf
    s_mov_b32 vcc_lo, 0xcccccccc
    s_mov_b32 vcc_hi, 0xcccccccc
    v_cndmask_b32_dpp v40, v48, v56, vcc quad_perm:[2,3,0,1] row_mask:0xf bank_mask:0xf
    v_cndmask_b32_dpp v41, v49, v57, vcc quad_perm:[2,3,0,1] row_mask:0xf bank_mask:0xf
    v_cndmask_b32_dpp v42, v50, v58, vcc quad_perm:[2,3,0,1] row_mask:0xf bank_mask:0xf
    v_cndmask_b32_dpp v43, v51, v59, vcc quad_perm:[2,3,0,1] row_mask:0xf bank_mask:0xf
    v_cndmask_b32_dpp v44, v52, v60, vcc quad_perm:[2,3,0,1] row_mask:0xf bank_mask:0xf
    v_cndmask_b32_dpp v45, v53, v61, vcc quad_perm:[2,3,0,1] row_mask:0xf bank_mask:0xf
    v_cndmask_b32_dpp v46, v54, v62, vcc quad_perm:[2,3,0,1] row_mask:0xf bank_mask:0xf
    v_cndmask_b32_dpp v47, v55, v63, vcc quad_perm:[2,3,0,1] row_mask:0xf bank_mask:0xf
    s_lshl_b32 s51, s34, 18
    s_add_u32 s51, s51, s33
    s_add_u32 s34, s34, 1
    s_cmp_eq_u32 s34, 10
    s_cselect_b32 s34, 0, s34
    s_add_u32 s35, s51, 0
    buffer_store_dwordx4 v[32:35], v20, s[8:11], s35 offen sc1
    s_add_u32 s35, s51, 4096
    buffer_store_dwordx4 v[36:39], v20, s[8:11], s35 offen sc1
    s_add_u32 s35, s51, 8192
    buffer_store_dwordx4 v[40:43], v20, s[8:11], s35 offen sc1
    s_add_u32 s35, s51, 12288
    buffer_store_dwordx4 v[44:47], v20, s[8:11], s35 offen sc1
    s_add_u32 s44, s43, 0
    s_add_u32 m0, s52, 0
    s_nop 0
    buffer_load_dwordx4 v10, s[36:39], s44 offen nt lds
    s_add_u32 m0, s52, 1024
    s_nop 0
    buffer_load_dwordx4 v11, s[36:39], s44 offen nt lds
    s_add_u32 m0, s52, 2048
    s_nop 0
    buffer_load_dwordx4 v12, s[36:39], s44 offen nt lds
    s_add_u32 m0, s52, 3072
    s_nop 0
    buffer_load_dwordx4 v13, s[36:39], s44 offen nt lds
    s_add_u32 m0, s52, 4096
    s_nop 0
    buffer_load_dwordx4 v14, s[36:39], s44 offen nt lds
    s_add_u32 s44, s43, 40960
    s_add_u32 m0, s52, 5120
    s_nop 0
    buffer_load_dwordx4 v10, s[36:39], s44 offen nt lds
    s_add_u32 m0, s52, 6144
    s_nop 0
    buffer_load_dwordx4 v11, s[36:39], s44 offen nt lds
    s_add_u32 m0, s52, 7168
    s_nop 0
    buffer_load_dwordx4 v12, s[36:39], s44 offen nt lds
    s_add_u32 m0, s52, 8192
    s_nop 0
    buffer_load_dwordx4 v13, s[36:39], s44 offen nt lds
    s_add_u32 m0, s52, 9216
    s_nop 0
    buffer_load_dwordx4 v14, s[36:39], s44 offen nt lds
    s_add_u32 s44, s43, 81920
    buffer_load_dwordx4 v[124:127], v10, s[36:39], s44 offen nt
    buffer_load_dwordx4 v[128:131], v11, s[36:39], s44 offen nt
    buffer_load_dwordx4 v[132:135], v12, s[36:39], s44 offen nt
    buffer_load_dwordx4 v[136:139], v13, s[36:39], s44 offen nt
    buffer_load_dwordx4 v[140:143], v14, s[36:39], s44 offen nt
    s_barrier
    v_add_u32 v28, s17, v1
    v_add_u32 v29, -10, v28
    v_min_u32 v28, v28, v29
    v_lshlrev_b32 v28, 8, v28
    v_mov_b32 v29, s12
    s_lshl_b32 s28, s40, 6
    s_lshl_b32 s29, s101, 2
    s_add_u32 s28, s28, s29
    s_add_u32 s28, s28, 14688256
    s_waitcnt vmcnt(15)
    s_mov_b64 exec, 3
    buffer_store_dword v29, v28, s[8:11], s28 offen sc1
    s_mov_b64 exec, -1
    s_barrier
    s_waitcnt vmcnt(6)
    ds_read_b64_tr_b16 v[64:65], v5 offset:0
    ds_read_b64_tr_b16 v[66:67], v5 offset:1280
    ds_read_b64_tr_b16 v[68:69], v5 offset:8
    ds_read_b64_tr_b16 v[70:71], v5 offset:1288
    ds_read_b64_tr_b16 v[72:73], v5 offset:64
    ds_read_b64_tr_b16 v[74:75], v5 offset:1344
    ds_read_b64_tr_b16 v[76:77], v5 offset:72
    ds_read_b64_tr_b16 v[78:79], v5 offset:1352
    ds_read_b64_tr_b16 v[80:81], v6 offset:128
    ds_read_b64_tr_b16 v[82:83], v6 offset:1408
    ds_read_b64_tr_b16 v[84:85], v5 offset:5120
    ds_read_b64_tr_b16 v[86:87], v5 offset:6400
    ds_read_b64_tr_b16 v[88:89], v5 offset:5128
    ds_read_b64_tr_b16 v[90:91], v5 offset:6408
    ds_read_b64_tr_b16 v[92:93], v5 offset:5184
    ds_read_b64_tr_b16 v[94:95], v5 offset:6464
    ds_read_b64_tr_b16 v[96:97], v5 offset:5192
    ds_read_b64_tr_b16 v[98:99], v5 offset:6472
    ds_read_b64_tr_b16 v[100:101], v6 offset:5248
    ds_read_b64_tr_b16 v[102:103], v6 offset:6528
    s_waitcnt lgkmcnt(0)
    s_add_u32 s49, s45, 0
    buffer_store_dwordx4 v[64:67], v7, s[8:11], s49 offen sc1
    s_add_u32 s49, s45, 1024
    buffer_store_dwordx4 v[68:71], v7, s[8:11], s49 offen sc1
    s_add_u32 s49, s45, 2048
    buffer_store_dwordx4 v[72:75], v7, s[8:11], s49 offen sc1
    s_add_u32 s49, s45, 3072
    buffer_store_dwordx4 v[76:79], v7, s[8:11], s49 offen sc1
    s_add_u32 s49, s45, 4096
    buffer_store_dwordx4 v[80:83], v7, s[8:11], s49 offen sc1
    s_add_u32 s49, s45, 5120
    buffer_store_dwordx4 v[84:87], v7, s[8:11], s49 offen sc1
    s_add_u32 s49, s45, 6144
    buffer_store_dwordx4 v[88:91], v7, s[8:11], s49 offen sc1
    s_add_u32 s49, s45, 7168
    buffer_store_dwordx4 v[92:95], v7, s[8:11], s49 offen sc1
    s_add_u32 s49, s45, 8192
    buffer_store_dwordx4 v[96:99], v7, s[8:11], s49 offen sc1
    s_add_u32 s49, s45, 9216
    buffer_store_dwordx4 v[100:103], v7, s[8:11], s49 offen sc1
    s_waitcnt vmcnt(11)
    ds_write_b128 v23, v[124:127] offset:0
    ds_write_b128 v23, v[128:131] offset:1024
    ds_write_b128 v23, v[132:135] offset:2048
    ds_write_b128 v23, v[136:139] offset:3072
    ds_write_b128 v23, v[140:143] offset:4096
    ds_read_b64_tr_b16 v[104:105], v5 offset:0
    ds_read_b64_tr_b16 v[106:107], v5 offset:1280
    ds_read_b64_tr_b16 v[108:109], v5 offset:8
    ds_read_b64_tr_b16 v[110:111], v5 offset:1288
    ds_read_b64_tr_b16 v[112:113], v5 offset:64
    ds_read_b64_tr_b16 v[114:115], v5 offset:1344
    ds_read_b64_tr_b16 v[116:117], v5 offset:72
    ds_read_b64_tr_b16 v[118:119], v5 offset:1352
    ds_read_b64_tr_b16 v[120:121], v6 offset:128
    ds_read_b64_tr_b16 v[122:123], v6 offset:1408
    s_waitcnt lgkmcnt(0)
    s_add_u32 s49, s45, 10240
    buffer_store_dwordx4 v[104:107], v7, s[8:11], s49 offen sc1
    s_add_u32 s49, s45, 11264
    buffer_store_dwordx4 v[108:111], v7, s[8:11], s49 offen sc1
    s_add_u32 s49, s45, 12288
    buffer_store_dwordx4 v[112:115], v7, s[8:11], s49 offen sc1
    s_add_u32 s49, s45, 13312
    buffer_store_dwordx4 v[116:119], v7, s[8:11], s49 offen sc1
    s_add_u32 s49, s45, 14336
    buffer_store_dwordx4 v[120:123], v7, s[8:11], s49 offen sc1
    s_barrier
    s_barrier
    s_waitcnt vmcnt(0)
    s_lshl_b32 s28, s41, 7
    s_lshl_b32 s29, s42, 2
    s_add_u32 s28, s28, s29
    s_add_u32 s28, s28, 14692352
    v_mov_b32 v2, s12
    v_lshlrev_b32 v3, 0, v1
    s_mov_b64 exec, 1
    buffer_store_dword v2, v3, s[8:11], s28 offen sc1
    s_mov_b64 exec, -1
    s_cmp_lg_u32 s2, 8
    s_cbranch_scc1 Lauxend
    s_barrier
    s_barrier
    s_barrier
    s_mov_b32 s30, 0
Lp_73:
    ds_read_b32 v22, v21 offset:48
    s_waitcnt lgkmcnt(0)
    v_readfirstlane_b32 s31, v22
    s_cmp_ge_u32 s31, 2
    s_cbranch_scc1 Lpd_74
    s_sleep 8
    s_add_u32 s30, s30, 1
    s_cmp_lt_u32 s30, 262144
    s_cbranch_scc1 Lp_73
Lpd_74:
    v_lshrrev_b32 v8, 1, v1
    v_mul_u32_u24 v8, 256, v8
    v_and_b32 v9, 1, v1
    v_lshl_add_u32 v8, v9, 4, v8
    s_mov_b32 s30, 0
Lnwp:
    s_mov_b32 s28, 14942208
    buffer_load_dwordx4 v[32:35], v8, s[8:11], s28 offen sc1
    s_mov_b32 s28, 14950400
    buffer_load_dwordx4 v[36:39], v8, s[8:11], s28 offen sc1
    s_mov_b32 s28, 14958592
    buffer_load_dwordx4 v[40:43], v8, s[8:11], s28 offen sc1
    s_mov_b32 s28, 14966784
    buffer_load_dwordx4 v[44:47], v8, s[8:11], s28 offen sc1
    s_waitcnt vmcnt(0)
    v_xor_b32 v32, s12, v32
    v_xor_b32 v33, s12, v33
    v_xor_b32 v34, s12, v34
    v_xor_b32 v35, s12, v35
    v_xor_b32 v36, s12, v36
    v_xor_b32 v37, s12, v37
    v_xor_b32 v38, s12, v38
    v_xor_b32 v39, s12, v39
    v_xor_b32 v40, s12, v40
    v_xor_b32 v41, s12, v41
    v_xor_b32 v42, s12, v42
    v_xor_b32 v43, s12, v43
    v_xor_b32 v44, s12, v44
    v_xor_b32 v45, s12, v45
    v_xor_b32 v46, s12, v46
    v_xor_b32 v47, s12, v47
    v_or_b32 v32, v32, v33
    v_or_b32 v32, v32, v34
    v_or_b32 v32, v32, v35
    v_or_b32 v32, v32, v36
    v_or_b32 v32, v32, v37
    v_or_b32 v32, v32, v38
    v_or_b32 v32, v32, v39
    v_or_b32 v32, v32, v40
    v_or_b32 v32, v32, v41
    v_or_b32 v32, v32, v42
    v_or_b32 v32, v32, v43
    v_or_b32 v32, v32, v44
    v_or_b32 v32, v32, v45
    v_or_b32 v32, v32, v46
    v_or_b32 v32, v32, v47
    v_cmp_ne_u32 vcc, 0, v32
    s_cbranch_vccz Lnwd
    s_sleep 8
    s_add_u32 s30, s30, 1
    s_cmp_lt_u32 s30, 16384
    s_cbranch_scc1 Lnwp
Lnwd:
    s_mov_b32 s28, 14680064
    v_mov_b32 v26, s12
    v_lshlrev_b32 v27, 0, v1
    s_mov_b64 exec, 1
    buffer_store_dword v26, v27, s[8:11], s28 offen sc1
    s_mov_b64 exec, -1
Lauxend:
    s_endpgm
Lexit:
    s_waitcnt vmcnt(0)
    s_endpgm
Lcodeend:
.fill (35072 - (. - gated_mix__ssm_conv_s4d__geglu_ffn__prompt_kernel))/4, 4, 0xBF810000
.section .rodata,"a"
.p2align 6
.amdhsa_kernel gated_mix__ssm_conv_s4d__geglu_ffn__prompt_kernel
  .amdhsa_next_free_vgpr 256
  .amdhsa_next_free_sgpr 102
  .amdhsa_accum_offset 256
  .amdhsa_group_segment_fixed_size 0
  .amdhsa_kernarg_size 120
  .amdhsa_user_sgpr_count 2
  .amdhsa_user_sgpr_kernarg_segment_ptr 1
  .amdhsa_system_sgpr_workgroup_id_x 1
.end_amdhsa_kernel
```
